```python
import torch

def _softmax(x, axis=-1):
    return torch.softmax(x, dim=axis)
def _gelu(x):
    return torch.nn.functional.gelu(x, approximate="tanh")
def _silu(x):
    return torch.nn.functional.silu(x)
def _sigmoid(x):
    return torch.sigmoid(x)
def _layernorm(x, axis=-1, eps=1e-5):
    m = x.mean(dim=axis, keepdim=True)
    v = x.var(dim=axis, keepdim=True, unbiased=False)
    return (x - m) / torch.sqrt(v + eps)
def _scatter_add(tgt, idx, src, axis=0):
    return tgt.clone().index_add_(axis, idx, src)
def _segment_sum(src, seg, n):
    out = torch.zeros((n,) + src.shape[1:], dtype=src.dtype)
    return out.index_add_(0, seg, src)
def _pad(x, pw):
    flat = tuple(v for pair in reversed(pw) for v in pair)
    return torch.nn.functional.pad(x, flat)

kernel_name = 'concat_heads__gqa_block_cached__gqa_block_cached__near_ridge'

def setup_inputs():

    _w = (lambda a: (lambda t: t.to(torch.bfloat16) if t.is_floating_point() else t)(torch.as_tensor(a)))
    def _A_setup():
        B, Sq, D = 16, 48, 576
        Hq, Hkv, Sk, Dh = 32, 16, 48, 128
        assert Hq % Hkv == 0, (Hq, Hkv)
        return {
            "x": _w((lambda *s: torch.randn(*s, dtype=torch.bfloat16) * 0.8)(B, Sq, D)),
            "k_cache": _w((lambda *s: torch.randn(*s, dtype=torch.bfloat16) * 0.8)(B, Hkv, Sk, Dh)),
            "v_cache": _w((lambda *s: torch.randn(*s, dtype=torch.bfloat16) * 0.05)(B, Hkv, Sk, Dh)),
            "wq": _w((lambda *s: torch.randn(*s, dtype=torch.bfloat16) * 0.8)(D, Hq * Dh) * (D ** -0.5)),
            "wo": _w((lambda *s: torch.randn(*s, dtype=torch.bfloat16) * 0.05)(Hq * Dh, D) * ((Hq * Dh) ** -0.5)),
        }
    _A_in = _A_setup()

    def _B_setup():
        B, Sq, D = 16, 48, 576
        Hq, Hkv, Sk, Dh = 32, 16, 48, 128
        assert Hq % Hkv == 0, (Hq, Hkv)
        return {
            "x": _w((lambda *s: torch.randn(*s, dtype=torch.bfloat16) * 0.8)(B, Sq, D)),
            "k_cache": _w((lambda *s: torch.randn(*s, dtype=torch.bfloat16) * 0.8)(B, Hkv, Sk, Dh)),
            "v_cache": _w((lambda *s: torch.randn(*s, dtype=torch.bfloat16) * 0.05)(B, Hkv, Sk, Dh)),
            "wq": _w((lambda *s: torch.randn(*s, dtype=torch.bfloat16) * 0.8)(D, Hq * Dh) * (D ** -0.5)),
            "wo": _w((lambda *s: torch.randn(*s, dtype=torch.bfloat16) * 0.05)(Hq * Dh, D) * ((Hq * Dh) ** -0.5)),
        }
    _B_in = _B_setup()

    return {
        "A_x": _A_in["x"],
        "A_k_cache": _A_in["k_cache"],
        "A_v_cache": _A_in["v_cache"],
        "A_wq": _A_in["wq"],
        "A_wo": _A_in["wo"],
        "B_x": _B_in["x"],
        "B_k_cache": _B_in["k_cache"],
        "B_v_cache": _B_in["v_cache"],
        "B_wq": _B_in["wq"],
        "B_wo": _B_in["wo"],
    }

def reference(A_x, A_k_cache, A_v_cache, A_wq, A_wo, B_x, B_k_cache, B_v_cache, B_wq, B_wo):
    def _A_ref(x, k_cache, v_cache, wq, wo):
        B, Sq, D = x.shape
        Hq, Dh = 32, 128
        Hkv = k_cache.shape[1]
        rep = Hq // Hkv
        q = (lambda x, *d: x.permute(*d))((x @ wq).reshape(B, Sq, Hq, Dh), 0, 2, 1, 3)
        k = (lambda x, n, axis: torch.repeat_interleave(x, n, dim=axis))(k_cache, rep, axis=1)
        v = (lambda x, n, axis: torch.repeat_interleave(x, n, dim=axis))(v_cache, rep, axis=1)
        scores = torch.einsum("bhqd,bhkd->bhqk", q, k) * (Dh ** -0.5)
        p = _softmax(scores, axis=-1)
        o = torch.einsum("bhqk,bhkd->bhqd", p, v)
        return (lambda x, *d: x.permute(*d))(o, 0, 2, 1, 3).reshape(B, Sq, Hq * Dh) @ wo

    def _B_ref(x, k_cache, v_cache, wq, wo):
        B, Sq, D = x.shape
        Hq, Dh = 32, 128
        Hkv = k_cache.shape[1]
        rep = Hq // Hkv
        q = (lambda x, *d: x.permute(*d))((x @ wq).reshape(B, Sq, Hq, Dh), 0, 2, 1, 3)
        k = (lambda x, n, axis: torch.repeat_interleave(x, n, dim=axis))(k_cache, rep, axis=1)
        v = (lambda x, n, axis: torch.repeat_interleave(x, n, dim=axis))(v_cache, rep, axis=1)
        scores = torch.einsum("bhqd,bhkd->bhqk", q, k) * (Dh ** -0.5)
        p = _softmax(scores, axis=-1)
        o = torch.einsum("bhqk,bhkd->bhqd", p, v)
        return (lambda x, *d: x.permute(*d))(o, 0, 2, 1, 3).reshape(B, Sq, Hq * Dh) @ wo

    a = _A_ref(A_x, A_k_cache, A_v_cache, A_wq, A_wo)
    b = _B_ref(B_x, B_k_cache, B_v_cache, B_wq, B_wo)
    return torch.concatenate([a, b], axis=-1)
```

```asm
; @launch grid=(256,1,1) block=(512,1,1) lds=163840
.amdgcn_target "amdgcn-amd-amdhsa--gfx950"
.text
.globl concat_heads__gqa_block_cached__gqa_block_cached__near_ridge_kernel
.p2align 8
.type concat_heads__gqa_block_cached__gqa_block_cached__near_ridge_kernel,@function
concat_heads__gqa_block_cached__gqa_block_cached__near_ridge_kernel:
  s_cmp_ge_u32 s2, 256
  s_cbranch_scc1 L_end
  s_bfe_u32 s4, s2, 0x10002
  s_mul_i32 s44, s4, 40
  s_add_u32 s46, s0, s44
  s_addc_u32 s47, s1, 0
  s_load_dwordx8 s[32:39], s[46:47], 0
  s_load_dwordx2 s[40:41], s[46:47], 32
  s_load_dwordx4 s[80:83], s[0:1], 80
  s_load_dwordx2 s[42:43], s[0:1], 96
  v_lshrrev_b32 v1, 6, v0
  s_bfe_u32 s5, s2, 0x30003
  v_readfirstlane_b32 s7, v1
  s_lshr_b32 s71, s2, 6
  s_and_b32 s3, s2, 3
  s_lshl2_add_u32 s6, s3, s71
  v_and_b32 v0, 63, v0
  s_cmp_lt_u32 s7, 4
  s_cbranch_scc1 L_compute
L_loader:
  s_and_b32 s48, s7, 3
  v_lshrrev_b32 v4, 5, v0
  v_lshlrev_b32 v4, 17, v4
  v_and_b32 v2, 31, v0
  v_lshl_add_u32 v10, v2, 4, v4
  s_and_b32 s57, s48, 1
  s_lshr_b32 s49, s48, 1
  s_lshl_b32 s50, s6, 9
  s_lshl_b32 s44, s57, 15
  s_add_u32 s50, s50, s44
  s_lshl_b32 s44, s49, 18
  s_add_u32 s50, s50, s44
  s_mul_i32 s52, s48, 8448
  v_lshrrev_b32 v4, 3, v0
  v_mul_u32_u24 v4, 1152, v4
  v_and_b32 v2, 7, v0
  v_lshrrev_b32 v3, 4, v0
  v_xor_b32 v2, v2, v3
  s_lshl_b32 s44, s57, 2
  v_xor_b32 v2, s44, v2
  v_lshl_add_u32 v11, v2, 4, v4
  v_xor_b32 v2, 4, v2
  v_lshl_add_u32 v12, v2, 4, v4
  s_mul_i32 s51, s5, 110592
  s_mul_i32 s44, s48, 27648
  s_add_u32 s51, s51, s44
  s_mul_i32 s53, s48, 3072
  s_add_u32 s53, s53, 33792
  s_add_u32 s60, s5, s71
  s_and_b32 s60, s60, 1
  s_mul_i32 s60, s60, 5
  s_lshl_b32 s44, s60, 19
  s_add_u32 s50, s50, s44
  s_lshl_b32 s44, s60, 7
  s_add_u32 s51, s51, s44
  s_mov_b32 s55, 92160
  s_mov_b32 s61, 0
  s_mov_b32 s88, 0
  s_mov_b32 s22, 4718592
  s_mov_b32 s23, 0x20000
  s_mov_b32 s10, 884736
  s_mov_b32 s11, 0x20000
  s_waitcnt lgkmcnt(0)
  s_mov_b32 s20, s38
  s_mov_b32 s21, s39
  s_mov_b32 s8, s32
  s_mov_b32 s9, s33
  s_mov_b32 s101, 1
  s_mov_b32 s44, s50
  s_add_u32 m0, s55, s52
L_lq:
  s_nop 0
  buffer_load_dwordx4 v10, s[20:23], s44 offen  lds
  s_mov_b32 s45, s51
  s_add_u32 s46, s55, s53
  s_add_u32 m0, m0, 1056
  s_add_u32 s44, s44, 8192
  buffer_load_dwordx4 v10, s[20:23], s44 offen  lds
  s_add_u32 s47, s45, 9216
  s_add_u32 s86, s45, 18432
  s_add_u32 m0, m0, 1056
  s_add_u32 s44, s44, 8192
  buffer_load_dwordx4 v10, s[20:23], s44 offen  lds
  s_add_u32 s87, s46, 1024
  s_add_u32 s100, s46, 2048
  s_add_u32 m0, m0, 1056
  s_add_u32 s44, s44, 8192
  buffer_load_dwordx4 v10, s[20:23], s44 offen  lds
  s_add_u32 s50, s50, 524288
  s_add_u32 s51, s51, 128
  s_add_u32 s60, s60, 1
  s_add_u32 m0, m0, 1056
  s_add_u32 s44, s44, 40960
  buffer_load_dwordx4 v10, s[20:23], s44 offen  lds
  s_cmp_eq_u32 s60, 9
  s_cselect_b32 s99, 4718592, 0
  s_cselect_b32 s98, 1152, 0
  s_add_u32 m0, m0, 1056
  s_add_u32 s44, s44, 8192
  buffer_load_dwordx4 v10, s[20:23], s44 offen  lds
  s_sub_u32 s50, s50, s99
  s_sub_u32 s51, s51, s98
  s_add_u32 s55, s55, 46080
  s_add_u32 m0, m0, 1056
  s_add_u32 s44, s44, 8192
  buffer_load_dwordx4 v10, s[20:23], s44 offen  lds
  s_cmp_eq_u32 s55, 138240
  s_cselect_b32 s55, 0, s55
  s_add_u32 s61, s61, 1
  s_add_u32 m0, m0, 1056
  s_add_u32 s44, s44, 8192
  buffer_load_dwordx4 v10, s[20:23], s44 offen  lds
  s_add_u32 s99, s55, s52
  s_mov_b32 m0, s46
  s_mov_b32 s44, s50
  s_cmp_lg_u32 s61, s101
  buffer_load_dwordx4 v11, s[8:11], s45 offen  lds
  s_mov_b32 m0, s87
  s_nop 0
  buffer_load_dwordx4 v12, s[8:11], s47 offen  lds
  s_mov_b32 m0, s100
  s_nop 0
  buffer_load_dwordx4 v11, s[8:11], s86 offen  lds
  s_mov_b32 m0, s99
  s_cbranch_scc0 L_spec
  s_waitcnt vmcnt(11)
L_lq_b:
  s_barrier
  s_branch L_lq
L_spec:
  s_cmp_eq_u32 s88, 2
  s_cbranch_scc1 L_lq_next
  s_cmp_eq_u32 s88, 1
  s_cbranch_scc1 L_setup
  s_add_u32 s101, s101, 1
  s_cmp_lt_u32 s61, 2
  s_cbranch_scc1 L_lq
  s_mov_b32 s88, 1
  s_waitcnt vmcnt(11)
  s_barrier
  s_branch L_lq
L_setup:
  s_mov_b32 s88, 2
  s_mov_b32 s89, 8000000
  s_mov_b32 s12, s34
  s_mov_b32 s13, s35
  s_mov_b32 s14, 3145728
  s_mov_b32 s15, 0x20000
  s_mov_b32 s16, s36
  s_mov_b32 s17, s37
  s_mov_b32 s18, 3145728
  s_mov_b32 s19, 0x20000
  s_mov_b32 s24, s40
  s_mov_b32 s25, s41
  s_mov_b32 s26, 4718592
  s_mov_b32 s27, 0x20000
  s_mov_b32 s28, s42
  s_mov_b32 s29, s43
  s_mov_b32 s30, 268435456
  s_mov_b32 s31, 0x20000
  s_mov_b32 s72, s80
  s_mov_b32 s73, s81
  s_mov_b32 s74, 1769472
  s_mov_b32 s75, 0x20000
  s_mov_b32 s76, s82
  s_mov_b32 s77, s83
  s_mov_b32 s78, 256
  s_mov_b32 s79, 0x20000
  v_lshrrev_b32 v4, 4, v0
  v_and_b32 v2, 15, v0
  v_xor_b32 v3, v2, v4
  v_lshlrev_b32 v3, 4, v3
  v_lshl_add_u32 v13, v4, 8, v3
  s_mul_i32 s44, s49, 13056
  s_mul_i32 s45, s57, 6528
  s_add_u32 s44, s44, s45
  s_add_u32 s44, s44, 112128
  v_add_u32 v13, s44, v13
  v_mul_u32_u24 v16, 9216, v4
  v_lshl_add_u32 v16, v2, 4, v16
  v_lshlrev_b32 v26, 3, v2
  v_bfe_u32 v2, v0, 1, 3
  v_xor_b32 v2, v2, v4
  v_lshlrev_b32 v2, 5, v2
  v_and_b32 v3, 1, v0
  v_lshl_add_u32 v2, v3, 4, v2
  v_lshl_add_u32 v14, v4, 8, v2
  v_lshrrev_b32 v4, 3, v0
  v_mul_u32_u24 v4, 9216, v4
  v_and_b32 v2, 7, v0
  v_lshl_add_u32 v17, v2, 4, v4
  s_lshl1_add_u32 s56, s5, s49
  s_lshl4_add_u32 s56, s56, s6
  s_mul_i32 s56, s56, 12288
  s_mul_i32 s44, s57, 6144
  s_add_u32 s56, s56, s44
  s_mov_b32 s84, s56
  s_mul_i32 s85, s49, 12288
  s_add_u32 s85, s85, s44
  s_add_u32 s85, s85, 138240
  v_lshlrev_b32 v25, 4, v0
  v_and_b32 v18, 3, v0
  v_lshlrev_b32 v18, 2, v18
  v_add_u32 v18, 101408, v18
  s_lshl_b32 s44, s48, 2
  s_add_u32 s44, s44, 101376
  v_mov_b32 v19, s44
  v_mov_b32 v20, 101424
  s_mul_i32 s95, s3, 1179648
  s_lshl_b32 s44, s71, 8
  s_add_u32 s95, s95, s44
  s_add_u32 s44, s48, 0
  s_mul_i32 s45, s44, 86
  s_lshr_b32 s45, s45, 8
  s_mul_i32 s46, s45, 3
  s_sub_u32 s44, s44, s46
  s_add_u32 s44, s44, s71
  s_add_u32 s44, s44, 1
  s_and_b32 s44, s44, 3
  s_lshl_b32 s45, s45, 3
  s_lshr_b32 s45, 50397696, s45
  s_and_b32 s45, s45, 3
  s_lshl2_add_u32 s90, s44, s45
  s_add_u32 s44, s48, 4
  s_mul_i32 s45, s44, 86
  s_lshr_b32 s45, s45, 8
  s_mul_i32 s46, s45, 3
  s_sub_u32 s44, s44, s46
  s_add_u32 s44, s44, s71
  s_add_u32 s44, s44, 1
  s_and_b32 s44, s44, 3
  s_lshl_b32 s45, s45, 3
  s_lshr_b32 s45, 50397696, s45
  s_and_b32 s45, s45, 3
  s_lshl2_add_u32 s91, s44, s45
  s_add_u32 s44, s48, 8
  s_mul_i32 s45, s44, 86
  s_lshr_b32 s45, s45, 8
  s_mul_i32 s46, s45, 3
  s_sub_u32 s44, s44, s46
  s_add_u32 s44, s44, s71
  s_add_u32 s44, s44, 1
  s_and_b32 s44, s44, 3
  s_lshl_b32 s45, s45, 3
  s_lshr_b32 s45, 50397696, s45
  s_and_b32 s45, s45, 3
  s_lshl2_add_u32 s92, s44, s45
  s_and_b32 s44, s2, 7
  s_lshl3_add_u32 s44, s44, s5
  s_lshl_b32 s93, s44, 10
  s_add_u32 s93, s93, 22020096
  s_mul_i32 s54, s44, 196608
  v_lshrrev_b32 v2, 1, v0
  v_mul_u32_u24 v2, 1152, v2
  v_and_b32 v3, 1, v0
  v_lshl_add_u32 v36, v3, 7, v2
  v_and_b32 v3, 7, v0
  v_mul_u32_u24 v37, 1152, v3
  s_lshr_b32 s94, s5, 1
  s_add_u32 s94, s94, 4
  s_mov_b32 s44, s50
  s_mov_b32 s101, s94
  s_waitcnt vmcnt(11)
  s_branch L_lq_b
L_lq_next:
  s_cmp_eq_u32 s61, 9
  s_cbranch_scc1 L_lq_done
  s_cmp_eq_u32 s61, s94
  s_cbranch_scc0 L_tw0
  s_lshl2_add_u32 s46, s5, s48
  s_mul_i32 s45, s46, 36864
  s_add_u32 s45, s45, s95
  buffer_load_dword v34, v36, s[24:27], s45 offen
  s_mul_i32 s45, s46, 9216
  s_mul_i32 s46, s6, 294912
  s_add_u32 s45, s45, s46
  s_add_u32 s45, s45, 1024
  buffer_load_dword v35, v37, s[24:27], s45 offen
  s_add_u32 s101, s101, 1
  s_bitcmp1_b32 s5, 0
  s_cbranch_scc0 L_w13
  buffer_load_dwordx4 v[40:43], v25, s[12:15], s56 offen offset:0 nt
  buffer_load_dwordx4 v[44:47], v25, s[12:15], s56 offen offset:1024 nt
  buffer_load_dwordx4 v[48:51], v25, s[12:15], s56 offen offset:2048 nt
  buffer_load_dwordx4 v[52:55], v25, s[12:15], s56 offen offset:3072 nt
  s_add_u32 s56, s56, 4096
  buffer_load_dwordx4 v[56:59], v25, s[12:15], s56 offen offset:0 nt
  buffer_load_dwordx4 v[60:63], v25, s[12:15], s56 offen offset:1024 nt
  s_waitcnt vmcnt(19)
  s_branch L_lq_b
L_tw0:
  s_mov_b32 s101, 9
  s_bitcmp1_b32 s5, 0
  s_cbranch_scc0 L_w13
  s_waitcnt vmcnt(19)
  s_branch L_lq_b
L_w13:
  s_waitcnt vmcnt(13)
  s_branch L_lq_b
L_lq_done:
  s_waitcnt vmcnt(11)
  s_barrier
  s_bitcmp1_b32 s5, 0
  s_cbranch_scc1 L_kh1
  buffer_load_dwordx4 v[40:43], v25, s[12:15], s56 offen offset:0 nt
  buffer_load_dwordx4 v[44:47], v25, s[12:15], s56 offen offset:1024 nt
  buffer_load_dwordx4 v[48:51], v25, s[12:15], s56 offen offset:2048 nt
  buffer_load_dwordx4 v[52:55], v25, s[12:15], s56 offen offset:3072 nt
  s_add_u32 s56, s56, 4096
  buffer_load_dwordx4 v[56:59], v25, s[12:15], s56 offen offset:0 nt
  buffer_load_dwordx4 v[60:63], v25, s[12:15], s56 offen offset:1024 nt
L_kh1:
  s_mov_b32 m0, s85
  v_xor_b32 v15, 128, v14
  buffer_load_dwordx4 v14, s[16:19], s84 offen offset:0 nt lds
  buffer_load_dwordx4 v15, s[16:19], s84 offen offset:1024 nt lds
  buffer_load_dwordx4 v14, s[16:19], s84 offen offset:2048 nt lds
  buffer_load_dwordx4 v15, s[16:19], s84 offen offset:3072 nt lds
  s_add_u32 m0, m0, 4096
  s_add_u32 s84, s84, 4096
  buffer_load_dwordx4 v14, s[16:19], s84 offen offset:0 nt lds
  buffer_load_dwordx4 v15, s[16:19], s84 offen offset:1024 nt lds
  v_mov_b32 v29, 0
  buffer_load_dwordx2 v[32:33], v29, s[76:79], 0 offen sc1
  s_bitcmp1_b32 s5, 0
  s_cbranch_scc0 L_kh2
  ds_write_b128 v13, v[40:43] offset:0
  ds_write_b128 v13, v[44:47] offset:1088
  ds_write_b128 v13, v[48:51] offset:2176
  ds_write_b128 v13, v[52:55] offset:3264
  ds_write_b128 v13, v[56:59] offset:4352
  ds_write_b128 v13, v[60:63] offset:5440
  s_waitcnt vmcnt(7)
L_kh2:
  v_min_u32 v2, 31, v0
  v_and_b32 v3, 20, v2
  v_lshlrev_b32 v2, 2, v2
  v_add_u32 v2, 101376, v2
  v_cmp_eq_u32 vcc, 20, v3
  s_nop 1
  v_cndmask_b32 v30, 0, 1, vcc
  ds_write_b32 v2, v30
  s_waitcnt vmcnt(13)
  s_barrier
  s_bitcmp1_b32 s5, 0
  s_cbranch_scc1 L_kh3
  s_waitcnt vmcnt(7)
  ds_write_b128 v13, v[40:43] offset:0
  ds_write_b128 v13, v[44:47] offset:1088
  ds_write_b128 v13, v[48:51] offset:2176
  ds_write_b128 v13, v[52:55] offset:3264
  ds_write_b128 v13, v[56:59] offset:4352
  ds_write_b128 v13, v[60:63] offset:5440
L_kh3:
  s_mov_b32 s98, 557855248
  s_mov_b32 s99, 891371573
  s_mov_b32 s100, 841023488
  s_mov_b32 s101, 2844222788
  s_lshl_b32 s44, s48, 2
  s_add_u32 s44, s44, 16
  s_lshr_b64 s[98:99], s[98:99], s44
  s_lshr_b64 s[100:101], s[100:101], s44
  v_mov_b32 v22, 101428
  v_mov_b32 v23, 101432
  v_mov_b32 v24, 1
  s_lshl2_add_u32 s44, s71, s48
  s_mul_i32 s44, s44, 73728
  s_add_u32 s45, s44, s95
  s_mul_i32 s47, s48, 16896
  s_mul_i32 s46, s3, 1179648
  s_waitcnt vmcnt(7) lgkmcnt(0)
  s_barrier
  s_mov_b32 m0, s47
  s_nop 0
  buffer_load_dwordx4 v16, s[24:27], s45 offen  lds
  s_add_u32 m0, m0, 1056
  s_add_u32 s45, s45, 1152
  buffer_load_dwordx4 v16, s[24:27], s45 offen  lds
  s_add_u32 m0, m0, 1056
  s_add_u32 s45, s45, 1152
  buffer_load_dwordx4 v16, s[24:27], s45 offen  lds
  s_add_u32 m0, m0, 1056
  s_add_u32 s45, s45, 1152
  buffer_load_dwordx4 v16, s[24:27], s45 offen  lds
  s_add_u32 m0, m0, 1056
  s_add_u32 s45, s45, 1152
  s_waitcnt vmcnt(4)
  ds_write_b32 v19, v24 offset:96
  buffer_load_dwordx4 v16, s[24:27], s45 offen  lds
  s_add_u32 m0, m0, 1056
  s_add_u32 s45, s45, 1152
  buffer_load_dwordx4 v16, s[24:27], s45 offen  lds
  s_add_u32 m0, m0, 1056
  s_add_u32 s45, s45, 1152
  buffer_load_dwordx4 v16, s[24:27], s45 offen  lds
  s_add_u32 m0, m0, 1056
  s_add_u32 s45, s45, 1152
  buffer_load_dwordx4 v16, s[24:27], s45 offen  lds
  s_add_u32 m0, m0, 1056
  s_add_u32 s45, s45, 28800
  buffer_load_dwordx4 v16, s[24:27], s45 offen  lds
  s_add_u32 m0, m0, 1056
  s_add_u32 s45, s45, 1152
  buffer_load_dwordx4 v16, s[24:27], s45 offen  lds
  s_add_u32 m0, m0, 1056
  s_add_u32 s45, s45, 1152
  buffer_load_dwordx4 v16, s[24:27], s45 offen  lds
  s_add_u32 m0, m0, 1056
  s_add_u32 s45, s45, 1152
  buffer_load_dwordx4 v16, s[24:27], s45 offen  lds
  s_add_u32 m0, m0, 1056
  s_add_u32 s45, s45, 1152
  buffer_load_dwordx4 v16, s[24:27], s45 offen  lds
  s_add_u32 m0, m0, 1056
  s_add_u32 s45, s45, 1152
  buffer_load_dwordx4 v16, s[24:27], s45 offen  lds
  s_add_u32 m0, m0, 1056
  s_add_u32 s45, s45, 1152
  buffer_load_dwordx4 v16, s[24:27], s45 offen  lds
  s_add_u32 m0, m0, 1056
  s_add_u32 s45, s45, 1152
  buffer_load_dwordx4 v16, s[24:27], s45 offen  lds
  s_add_u32 s45, s44, s46
  s_add_u32 s45, s45, 1024
  s_mul_i32 s46, s48, 8448
  s_add_u32 s47, s46, 67584
  s_mov_b32 s55, 0
  s_mul_i32 s56, s55, 1056
  s_add_u32 m0, s56, s47
  s_mul_i32 s56, s55, 1152
  s_add_u32 s56, s56, s45
  buffer_load_dwordx4 v17, s[24:27], s56 offen  lds
  s_add_u32 s55, s55, 1
  s_and_b32 s55, s55, 7
  s_mul_i32 s56, s55, 1056
  s_add_u32 m0, s56, s47
  s_mul_i32 s56, s55, 1152
  s_add_u32 s56, s56, s45
  buffer_load_dwordx4 v17, s[24:27], s56 offen  lds
  s_add_u32 s55, s55, 1
  s_and_b32 s55, s55, 7
  s_mul_i32 s56, s55, 1056
  s_add_u32 m0, s56, s47
  s_mul_i32 s56, s55, 1152
  s_add_u32 s56, s56, s45
  buffer_load_dwordx4 v17, s[24:27], s56 offen  lds
  s_add_u32 s55, s55, 1
  s_and_b32 s55, s55, 7
  s_mul_i32 s56, s55, 1056
  s_add_u32 m0, s56, s47
  s_mul_i32 s56, s55, 1152
  s_add_u32 s56, s56, s45
  buffer_load_dwordx4 v17, s[24:27], s56 offen  lds
  s_add_u32 s55, s55, 1
  s_and_b32 s55, s55, 7
  s_mul_i32 s56, s55, 1056
  s_add_u32 m0, s56, s47
  s_mul_i32 s56, s55, 1152
  s_add_u32 s56, s56, s45
  buffer_load_dwordx4 v17, s[24:27], s56 offen  lds
  s_add_u32 s55, s55, 1
  s_and_b32 s55, s55, 7
  s_mul_i32 s56, s55, 1056
  s_add_u32 m0, s56, s47
  s_mul_i32 s56, s55, 1152
  s_add_u32 s56, s56, s45
  buffer_load_dwordx4 v17, s[24:27], s56 offen  lds
  s_add_u32 s55, s55, 1
  s_and_b32 s55, s55, 7
  s_mul_i32 s56, s55, 1056
  s_add_u32 m0, s56, s47
  s_mul_i32 s56, s55, 1152
  s_add_u32 s56, s56, s45
  buffer_load_dwordx4 v17, s[24:27], s56 offen  lds
  s_add_u32 s55, s55, 1
  s_and_b32 s55, s55, 7
  s_mul_i32 s56, s55, 1056
  s_add_u32 m0, s56, s47
  s_mul_i32 s56, s55, 1152
  s_add_u32 s56, s56, s45
  buffer_load_dwordx4 v17, s[24:27], s56 offen  lds
  s_add_u32 s60, s48, 4
  v_mov_b32 v31, s60
  s_waitcnt vmcnt(0)
  ds_write_b32 v19, v31
  v_readfirstlane_b32 s58, v32
  v_readfirstlane_b32 s59, v33
  s_nop 0
  s_cmp_lg_u32 s58, 0
  s_cbranch_scc1 L_nok
  v_mov_b32 v29, 0
L_nonl:
  buffer_load_dwordx2 v[30:31], v29, s[76:79], 0 offen sc1
  s_waitcnt vmcnt(0)
  v_readfirstlane_b32 s58, v30
  v_readfirstlane_b32 s59, v31
  s_sub_u32 s89, s89, 1
  s_bitcmp1_b32 s89, 31
  s_cbranch_scc1 L_nonxl
  s_cmp_eq_u32 s58, 0
  s_cbranch_scc1 L_nonl
L_nonxl:
L_nok:
  v_add_u32 v21, -16, v18
  s_mov_b32 s61, 0
L_st:
  s_lshr_b32 s44, s90, 2
  s_lshl_b32 s44, s44, 8
  s_and_b32 s45, s90, 1
  s_lshl_b32 s45, s45, 7
  s_add_u32 s44, s44, s45
  s_and_b32 s45, s90, 2
  s_lshl_b32 s45, s45, 3
  s_add_u32 s44, s44, s45
  s_add_u32 s88, s44, s93
  s_and_b32 s84, s100, 15
  s_and_b32 s44, s98, 15
  s_mul_i32 s47, s44, 16896
  s_lshr_b64 s[98:99], s[98:99], 16
  s_lshr_b64 s[100:101], s[100:101], 16
  s_mul_i32 s45, s90, 73728
  s_add_u32 s45, s45, s95
  s_add_u32 s60, s48, s61
  s_cmp_eq_u32 s61, 0
  s_cbranch_scc0 L_fp0
L_lwpd:
  ds_read_b32 v30, v21
  s_waitcnt lgkmcnt(0)
  v_cmp_gt_u32 vcc, 1, v30
  s_sub_u32 s89, s89, 1
  s_bitcmp1_b32 s89, 31
  s_cbranch_scc1 L_lwxpd
  s_cbranch_vccz L_lwxpd
  s_sleep 1
  s_branch L_lwpd
L_lwxpd:
L_fp0:
  v_add_u32 v33, s47, v25
  s_mov_b32 s87, 7
L_ev:
  s_bitcmp1_b32 s87, 2
  s_cbranch_scc0 L_ev1
  s_load_dwordx8 s[16:23], s[28:29], s88 glc
  s_waitcnt lgkmcnt(0)
  s_xor_b64 s[20:21], s[20:21], s[58:59]
  s_xor_b64 s[22:23], s[22:23], s[58:59]
  s_or_b64 s[14:15], s[20:21], s[22:23]
  s_xor_b64 s[8:9], s[16:17], s[58:59]
  s_xor_b64 s[10:11], s[18:19], s[58:59]
  s_or_b64 s[8:9], s[8:9], s[10:11]
  s_cselect_b32 s44, -1, 3
  s_and_b32 s87, s87, s44
L_ev1:
  ds_read_b32 v30, v18
  s_waitcnt lgkmcnt(0)
  v_cmp_gt_u32 vcc, s60, v30
  v_cmp_gt_u32 s[12:13], s84, v30
  s_and_b32 s44, s87, 6
  s_cmp_eq_u32 s44, 2
  s_cbranch_scc0 L_ev2
  s_cbranch_vccnz L_ev2
  s_mul_i32 s44, s60, 52
  s_lshr_b32 s44, s44, 8
  s_mul_i32 s44, s44, 5
  s_sub_u32 s44, s60, s44
  s_mul_i32 s44, s44, 12288
  s_add_u32 m0, s44, 102400
  s_mul_i32 s44, s90, 12288
  s_add_u32 s44, s44, s54
  buffer_load_dwordx4 v25, s[28:31], s44 offen offset:0 sc1 lds
  buffer_load_dwordx4 v25, s[28:31], s44 offen offset:1024 sc1 lds
  buffer_load_dwordx4 v25, s[28:31], s44 offen offset:2048 sc1 lds
  buffer_load_dwordx4 v25, s[28:31], s44 offen offset:3072 sc1 lds
  s_add_u32 m0, m0, 4096
  s_add_u32 s44, s44, 4096
  buffer_load_dwordx4 v25, s[28:31], s44 offen offset:0 sc1 lds
  buffer_load_dwordx4 v25, s[28:31], s44 offen offset:1024 sc1 lds
  buffer_load_dwordx4 v25, s[28:31], s44 offen offset:2048 sc1 lds
  buffer_load_dwordx4 v25, s[28:31], s44 offen offset:3072 sc1 lds
  s_add_u32 m0, m0, 4096
  s_add_u32 s44, s44, 4096
  buffer_load_dwordx4 v25, s[28:31], s44 offen offset:0 sc1 lds
  buffer_load_dwordx4 v25, s[28:31], s44 offen offset:1024 sc1 lds
  buffer_load_dwordx4 v25, s[28:31], s44 offen offset:2048 sc1 lds
  buffer_load_dwordx4 v25, s[28:31], s44 offen offset:3072 sc1 lds
  s_and_b32 s87, s87, 1
L_ev2:
  s_bitcmp1_b32 s87, 0
  s_cbranch_scc0 L_ev3
  s_cmp_eq_u64 s[12:13], 0
  s_cbranch_scc0 L_ev3
  s_mov_b32 m0, s47
  s_nop 0
  buffer_load_dwordx4 v16, s[24:27], s45 offen  lds
  s_add_u32 m0, m0, 1056
  s_add_u32 s45, s45, 1152
  buffer_load_dwordx4 v16, s[24:27], s45 offen  lds
  s_add_u32 m0, m0, 1056
  s_add_u32 s45, s45, 1152
  buffer_load_dwordx4 v16, s[24:27], s45 offen  lds
  s_add_u32 m0, m0, 1056
  s_add_u32 s45, s45, 1152
  buffer_load_dwordx4 v16, s[24:27], s45 offen  lds
  s_add_u32 m0, m0, 1056
  s_add_u32 s45, s45, 1152
  buffer_load_dwordx4 v16, s[24:27], s45 offen  lds
  s_add_u32 m0, m0, 1056
  s_add_u32 s45, s45, 1152
  buffer_load_dwordx4 v16, s[24:27], s45 offen  lds
  s_add_u32 m0, m0, 1056
  s_add_u32 s45, s45, 1152
  buffer_load_dwordx4 v16, s[24:27], s45 offen  lds
  s_add_u32 m0, m0, 1056
  s_add_u32 s45, s45, 1152
  buffer_load_dwordx4 v16, s[24:27], s45 offen  lds
  s_add_u32 m0, m0, 1056
  s_add_u32 s45, s45, 28800
  buffer_load_dwordx4 v16, s[24:27], s45 offen  lds
  s_add_u32 m0, m0, 1056
  s_add_u32 s45, s45, 1152
  buffer_load_dwordx4 v16, s[24:27], s45 offen  lds
  s_add_u32 m0, m0, 1056
  s_add_u32 s45, s45, 1152
  buffer_load_dwordx4 v16, s[24:27], s45 offen  lds
  s_add_u32 m0, m0, 1056
  s_add_u32 s45, s45, 1152
  buffer_load_dwordx4 v16, s[24:27], s45 offen  lds
  s_add_u32 m0, m0, 1056
  s_add_u32 s45, s45, 1152
  buffer_load_dwordx4 v16, s[24:27], s45 offen  lds
  s_add_u32 m0, m0, 1056
  s_add_u32 s45, s45, 1152
  buffer_load_dwordx4 v16, s[24:27], s45 offen  lds
  s_add_u32 m0, m0, 1056
  s_add_u32 s45, s45, 1152
  buffer_load_dwordx4 v16, s[24:27], s45 offen  lds
  s_add_u32 m0, m0, 1056
  s_add_u32 s45, s45, 1152
  buffer_load_dwordx4 v16, s[24:27], s45 offen  lds
  s_and_b32 s87, s87, 6
L_ev3:
  s_cmp_eq_u32 s87, 0
  s_cbranch_scc1 L_evx
  s_bitcmp1_b32 s87, 2
  s_cbranch_scc1 L_ev4
  s_sleep 1
L_ev4:
  s_sub_u32 s89, s89, 1
  s_bitcmp1_b32 s89, 31
  s_cbranch_scc0 L_ev
L_evx:
  s_add_u32 s60, s60, 8
  v_mov_b32 v31, s60
  s_mov_b32 s90, s91
  s_mov_b32 s91, s92
  s_waitcnt vmcnt(0) lgkmcnt(0)
  ds_write_b32 v19, v31
  s_add_u32 s61, s61, 4
  s_cmp_lt_u32 s61, 12
  s_cbranch_scc1 L_st
  s_setprio 3
  s_mov_b32 s86, 0x3f80
  s_mov_b32 s85, 0x3f800000
  s_lshl3_add_u32 s47, s4, s5
  s_cmp_eq_u32 s48, 0
  s_cbranch_scc1 L_fin_u
  s_sub_u32 s48, s48, 1
  s_lshl2_add_u32 s44, s47, s71
  s_lshl2_add_u32 s44, s44, s3
  s_lshl_b32 s57, s44, 7
  s_add_u32 s57, s57, 22085632
  s_mul_i32 s49, s44, 24576
  s_lshl_b32 s45, s48, 11
  s_add_u32 s49, s49, s45
  s_add_u32 s49, s49, 12582912
  s_add_u32 s46, s3, 1
  s_and_b32 s46, s46, 3
  s_mul_i32 s46, s46, 6144
  s_add_u32 s52, s49, s46
  s_add_u32 s46, s3, 2
  s_and_b32 s46, s46, 3
  s_mul_i32 s46, s46, 6144
  s_add_u32 s53, s49, s46
  s_add_u32 s46, s3, 3
  s_and_b32 s46, s46, 3
  s_mul_i32 s46, s46, 6144
  s_add_u32 s54, s49, s46
  s_add_u32 s45, s45, 0
  v_add_u32 v29, s45, v25
  v_and_b32 v27, 3, v0
  v_lshlrev_b32 v27, 3, v27
  v_and_b32 v2, 15, v0
  v_mul_u32_u24 v2, 2304, v2
  v_lshrrev_b32 v3, 4, v0
  v_lshl_add_u32 v28, v3, 3, v2
  s_and_b32 s44, s3, 1
  s_lshl1_add_u32 s44, s5, s44
  s_mul_i32 s60, s44, 110592
  s_mul_i32 s44, s48, 36864
  s_add_u32 s60, s60, s44
  s_mul_i32 s44, s4, 1152
  s_add_u32 s60, s60, s44
  s_lshl_b32 s44, s71, 8
  s_add_u32 s60, s60, s44
  s_lshr_b32 s44, s3, 1
  s_lshl_b32 s44, s44, 7
  s_add_u32 s60, s60, s44
L_lwf:
  ds_read_b32 v30, v20
  s_waitcnt lgkmcnt(0)
  v_cmp_gt_u32 vcc, 1, v30
  s_sub_u32 s89, s89, 1
  s_bitcmp1_b32 s89, 31
  s_cbranch_scc1 L_lwxf
  s_cbranch_vccz L_lwxf
  s_sleep 1
  s_branch L_lwf
L_lwxf:
  ds_read_b128 v[32:35], v29
  ds_read_b128 v[36:39], v29 offset:1024
  s_waitcnt lgkmcnt(0)
  v_lshlrev_b32 v64, 16, v32
  v_and_b32 v65, 0xffff0000, v32
  v_lshlrev_b32 v66, 16, v33
  v_and_b32 v67, 0xffff0000, v33
  v_lshlrev_b32 v68, 16, v34
  v_and_b32 v69, 0xffff0000, v34
  v_lshlrev_b32 v70, 16, v35
  v_and_b32 v71, 0xffff0000, v35
  v_lshlrev_b32 v72, 16, v36
  v_and_b32 v73, 0xffff0000, v36
  v_lshlrev_b32 v74, 16, v37
  v_and_b32 v75, 0xffff0000, v37
  v_lshlrev_b32 v76, 16, v38
  v_and_b32 v77, 0xffff0000, v38
  v_lshlrev_b32 v78, 16, v39
  v_and_b32 v79, 0xffff0000, v39
  s_add_u32 s88, s57, 0
L_spf:
  s_load_dwordx8 s[8:15], s[28:29], s88 glc
  s_waitcnt lgkmcnt(0)
  s_xor_b64 s[8:9], s[8:9], s[58:59]
  s_xor_b64 s[10:11], s[10:11], s[58:59]
  s_xor_b64 s[12:13], s[12:13], s[58:59]
  s_xor_b64 s[14:15], s[14:15], s[58:59]
  s_or_b64 s[8:9], s[8:9], s[10:11]
  s_or_b64 s[8:9], s[8:9], s[12:13]
  s_or_b64 s[8:9], s[8:9], s[14:15]
  s_cbranch_scc0 L_spxf
  s_sub_u32 s89, s89, 1
  s_bitcmp1_b32 s89, 31
  s_cbranch_scc0 L_spf
L_spxf:
  buffer_load_dwordx4 v[40:43], v25, s[28:31], s52 offen sc1
  buffer_load_dwordx4 v[44:47], v25, s[28:31], s52 offen offset:1024 sc1
  buffer_load_dwordx4 v[48:51], v25, s[28:31], s53 offen sc1
  buffer_load_dwordx4 v[52:55], v25, s[28:31], s53 offen offset:1024 sc1
  buffer_load_dwordx4 v[56:59], v25, s[28:31], s54 offen sc1
  buffer_load_dwordx4 v[60:63], v25, s[28:31], s54 offen offset:1024 sc1
  s_waitcnt vmcnt(4)
  v_dot2_f32_bf16 v64, v40, s86, v64
  v_dot2_f32_bf16 v65, v40, s85, v65
  v_dot2_f32_bf16 v66, v41, s86, v66
  v_dot2_f32_bf16 v67, v41, s85, v67
  v_dot2_f32_bf16 v68, v42, s86, v68
  v_dot2_f32_bf16 v69, v42, s85, v69
  v_dot2_f32_bf16 v70, v43, s86, v70
  v_dot2_f32_bf16 v71, v43, s85, v71
  v_dot2_f32_bf16 v72, v44, s86, v72
  v_dot2_f32_bf16 v73, v44, s85, v73
  v_dot2_f32_bf16 v74, v45, s86, v74
  v_dot2_f32_bf16 v75, v45, s85, v75
  v_dot2_f32_bf16 v76, v46, s86, v76
  v_dot2_f32_bf16 v77, v46, s85, v77
  v_dot2_f32_bf16 v78, v47, s86, v78
  v_dot2_f32_bf16 v79, v47, s85, v79
  s_waitcnt vmcnt(2)
  v_dot2_f32_bf16 v64, v48, s86, v64
  v_dot2_f32_bf16 v65, v48, s85, v65
  v_dot2_f32_bf16 v66, v49, s86, v66
  v_dot2_f32_bf16 v67, v49, s85, v67
  v_dot2_f32_bf16 v68, v50, s86, v68
  v_dot2_f32_bf16 v69, v50, s85, v69
  v_dot2_f32_bf16 v70, v51, s86, v70
  v_dot2_f32_bf16 v71, v51, s85, v71
  v_dot2_f32_bf16 v72, v52, s86, v72
  v_dot2_f32_bf16 v73, v52, s85, v73
  v_dot2_f32_bf16 v74, v53, s86, v74
  v_dot2_f32_bf16 v75, v53, s85, v75
  v_dot2_f32_bf16 v76, v54, s86, v76
  v_dot2_f32_bf16 v77, v54, s85, v77
  v_dot2_f32_bf16 v78, v55, s86, v78
  v_dot2_f32_bf16 v79, v55, s85, v79
  s_waitcnt vmcnt(0)
  v_dot2_f32_bf16 v64, v56, s86, v64
  v_dot2_f32_bf16 v65, v56, s85, v65
  v_dot2_f32_bf16 v66, v57, s86, v66
  v_dot2_f32_bf16 v67, v57, s85, v67
  v_dot2_f32_bf16 v68, v58, s86, v68
  v_dot2_f32_bf16 v69, v58, s85, v69
  v_dot2_f32_bf16 v70, v59, s86, v70
  v_dot2_f32_bf16 v71, v59, s85, v71
  v_dot2_f32_bf16 v72, v60, s86, v72
  v_dot2_f32_bf16 v73, v60, s85, v73
  v_dot2_f32_bf16 v74, v61, s86, v74
  v_dot2_f32_bf16 v75, v61, s85, v75
  v_dot2_f32_bf16 v76, v62, s86, v76
  v_dot2_f32_bf16 v77, v62, s85, v77
  v_dot2_f32_bf16 v78, v63, s86, v78
  v_dot2_f32_bf16 v79, v63, s85, v79
  s_nop 2
  v_cvt_pk_bf16_f32 v32, v64, v65
  v_cvt_pk_bf16_f32 v33, v66, v67
  v_cvt_pk_bf16_f32 v34, v68, v69
  v_cvt_pk_bf16_f32 v35, v70, v71
  v_cvt_pk_bf16_f32 v36, v72, v73
  v_cvt_pk_bf16_f32 v37, v74, v75
  v_cvt_pk_bf16_f32 v38, v76, v77
  v_cvt_pk_bf16_f32 v39, v78, v79
  buffer_store_dwordx2 v[32:33], v28, s[72:75], s60 offen offset:0
  buffer_store_dwordx2 v[34:35], v28, s[72:75], s60 offen offset:32
  buffer_store_dwordx2 v[36:37], v28, s[72:75], s60 offen offset:64
  buffer_store_dwordx2 v[38:39], v28, s[72:75], s60 offen offset:96
  s_branch L_fin4
L_fin_u:
  s_lshl_b32 s51, s47, 9
  s_add_u32 s51, s51, 22118400
  s_mul_i32 s50, s47, 196608
  s_mul_i32 s44, s6, 768
  s_add_u32 s50, s50, s44
  s_add_u32 s50, s50, 18874368
  v_lshlrev_b32 v27, 3, v0
  s_mul_i32 s44, s6, 48
  v_add_u32 v2, s44, v0
  v_lshrrev_b32 v3, 6, v2
  v_mul_u32_u24 v4, 86, v3
  v_lshrrev_b32 v4, 8, v4
  v_mul_u32_u24 v5, 3, v4
  v_sub_u32 v5, v3, v5
  v_and_b32 v6, 1, v4
  v_mul_u32_u24 v6, 48, v6
  v_lshl_add_u32 v6, v5, 4, v6
  v_and_b32 v5, 15, v2
  v_add_u32 v6, v6, v5
  v_mul_u32_u24 v6, 2304, v6
  v_lshrrev_b32 v4, 1, v4
  v_lshl_add_u32 v6, v4, 6, v6
  v_bfe_u32 v5, v2, 4, 2
  v_lshl_add_u32 v28, v5, 3, v6
  s_mul_i32 s60, s5, 221184
  s_mul_i32 s44, s4, 1152
  s_add_u32 s60, s60, s44
  s_add_u32 s60, s60, 1024
L_pollu:
  buffer_load_dwordx2 v[30:31], v27, s[28:31], s51 offen offset:0 sc1
  s_waitcnt vmcnt(0)
  v_cmp_eq_u64 vcc, s[58:59], v[30:31]
  s_sub_u32 s89, s89, 1
  s_bitcmp1_b32 s89, 31
  s_cbranch_scc1 L_pollxu
  s_nop 2
  s_cmp_eq_u64 vcc, exec
  s_cbranch_scc0 L_pollu
L_pollxu:
L_lwu8:
  ds_read_b32 v30, v20
  s_waitcnt lgkmcnt(0)
  v_cmp_gt_u32 vcc, 1, v30
  s_sub_u32 s89, s89, 1
  s_bitcmp1_b32 s89, 31
  s_cbranch_scc1 L_lwxu8
  s_cbranch_vccz L_lwxu8
  s_sleep 1
  s_branch L_lwu8
L_lwxu8:
  s_mov_b32 exec_hi, 0xffff
  buffer_load_dwordx4 v[40:43], v25, s[28:31], s50 offen sc1
  s_add_u32 s50, s50, 12288
  buffer_load_dwordx4 v[44:47], v25, s[28:31], s50 offen sc1
  s_add_u32 s50, s50, 12288
  buffer_load_dwordx4 v[48:51], v25, s[28:31], s50 offen sc1
  s_add_u32 s50, s50, 12288
  buffer_load_dwordx4 v[52:55], v25, s[28:31], s50 offen sc1
  s_add_u32 s50, s50, 12288
  buffer_load_dwordx4 v[56:59], v25, s[28:31], s50 offen sc1
  s_add_u32 s50, s50, 12288
  buffer_load_dwordx4 v[60:63], v25, s[28:31], s50 offen sc1
  s_add_u32 s50, s50, 12288
  buffer_load_dwordx4 v[64:67], v25, s[28:31], s50 offen sc1
  s_add_u32 s50, s50, 12288
  buffer_load_dwordx4 v[68:71], v25, s[28:31], s50 offen sc1
  s_add_u32 s50, s50, 12288
  buffer_load_dwordx4 v[72:75], v25, s[28:31], s50 offen sc1
  s_add_u32 s50, s50, 12288
  buffer_load_dwordx4 v[76:79], v25, s[28:31], s50 offen sc1
  s_add_u32 s50, s50, 12288
  buffer_load_dwordx4 v[80:83], v25, s[28:31], s50 offen sc1
  s_add_u32 s50, s50, 12288
  buffer_load_dwordx4 v[84:87], v25, s[28:31], s50 offen sc1
  s_add_u32 s50, s50, 12288
  buffer_load_dwordx4 v[88:91], v25, s[28:31], s50 offen sc1
  s_add_u32 s50, s50, 12288
  buffer_load_dwordx4 v[92:95], v25, s[28:31], s50 offen sc1
  s_add_u32 s50, s50, 12288
  buffer_load_dwordx4 v[96:99], v25, s[28:31], s50 offen sc1
  s_add_u32 s50, s50, 12288
  buffer_load_dwordx4 v[100:103], v25, s[28:31], s50 offen sc1
  s_waitcnt vmcnt(15)
  v_lshlrev_b32 v32, 16, v40
  v_and_b32 v33, 0xffff0000, v40
  v_lshlrev_b32 v34, 16, v41
  v_and_b32 v35, 0xffff0000, v41
  v_lshlrev_b32 v36, 16, v42
  v_and_b32 v37, 0xffff0000, v42
  v_lshlrev_b32 v38, 16, v43
  v_and_b32 v39, 0xffff0000, v43
  s_waitcnt vmcnt(14)
  v_dot2_f32_bf16 v32, v44, s86, v32
  v_dot2_f32_bf16 v33, v44, s85, v33
  v_dot2_f32_bf16 v34, v45, s86, v34
  v_dot2_f32_bf16 v35, v45, s85, v35
  v_dot2_f32_bf16 v36, v46, s86, v36
  v_dot2_f32_bf16 v37, v46, s85, v37
  v_dot2_f32_bf16 v38, v47, s86, v38
  v_dot2_f32_bf16 v39, v47, s85, v39
  s_waitcnt vmcnt(13)
  v_dot2_f32_bf16 v32, v48, s86, v32
  v_dot2_f32_bf16 v33, v48, s85, v33
  v_dot2_f32_bf16 v34, v49, s86, v34
  v_dot2_f32_bf16 v35, v49, s85, v35
  v_dot2_f32_bf16 v36, v50, s86, v36
  v_dot2_f32_bf16 v37, v50, s85, v37
  v_dot2_f32_bf16 v38, v51, s86, v38
  v_dot2_f32_bf16 v39, v51, s85, v39
  s_waitcnt vmcnt(12)
  v_dot2_f32_bf16 v32, v52, s86, v32
  v_dot2_f32_bf16 v33, v52, s85, v33
  v_dot2_f32_bf16 v34, v53, s86, v34
  v_dot2_f32_bf16 v35, v53, s85, v35
  v_dot2_f32_bf16 v36, v54, s86, v36
  v_dot2_f32_bf16 v37, v54, s85, v37
  v_dot2_f32_bf16 v38, v55, s86, v38
  v_dot2_f32_bf16 v39, v55, s85, v39
  s_waitcnt vmcnt(11)
  v_dot2_f32_bf16 v32, v56, s86, v32
  v_dot2_f32_bf16 v33, v56, s85, v33
  v_dot2_f32_bf16 v34, v57, s86, v34
  v_dot2_f32_bf16 v35, v57, s85, v35
  v_dot2_f32_bf16 v36, v58, s86, v36
  v_dot2_f32_bf16 v37, v58, s85, v37
  v_dot2_f32_bf16 v38, v59, s86, v38
  v_dot2_f32_bf16 v39, v59, s85, v39
  s_waitcnt vmcnt(10)
  v_dot2_f32_bf16 v32, v60, s86, v32
  v_dot2_f32_bf16 v33, v60, s85, v33
  v_dot2_f32_bf16 v34, v61, s86, v34
  v_dot2_f32_bf16 v35, v61, s85, v35
  v_dot2_f32_bf16 v36, v62, s86, v36
  v_dot2_f32_bf16 v37, v62, s85, v37
  v_dot2_f32_bf16 v38, v63, s86, v38
  v_dot2_f32_bf16 v39, v63, s85, v39
  s_waitcnt vmcnt(9)
  v_dot2_f32_bf16 v32, v64, s86, v32
  v_dot2_f32_bf16 v33, v64, s85, v33
  v_dot2_f32_bf16 v34, v65, s86, v34
  v_dot2_f32_bf16 v35, v65, s85, v35
  v_dot2_f32_bf16 v36, v66, s86, v36
  v_dot2_f32_bf16 v37, v66, s85, v37
  v_dot2_f32_bf16 v38, v67, s86, v38
  v_dot2_f32_bf16 v39, v67, s85, v39
  s_waitcnt vmcnt(8)
  v_dot2_f32_bf16 v32, v68, s86, v32
  v_dot2_f32_bf16 v33, v68, s85, v33
  v_dot2_f32_bf16 v34, v69, s86, v34
  v_dot2_f32_bf16 v35, v69, s85, v35
  v_dot2_f32_bf16 v36, v70, s86, v36
  v_dot2_f32_bf16 v37, v70, s85, v37
  v_dot2_f32_bf16 v38, v71, s86, v38
  v_dot2_f32_bf16 v39, v71, s85, v39
  s_waitcnt vmcnt(7)
  v_dot2_f32_bf16 v32, v72, s86, v32
  v_dot2_f32_bf16 v33, v72, s85, v33
  v_dot2_f32_bf16 v34, v73, s86, v34
  v_dot2_f32_bf16 v35, v73, s85, v35
  v_dot2_f32_bf16 v36, v74, s86, v36
  v_dot2_f32_bf16 v37, v74, s85, v37
  v_dot2_f32_bf16 v38, v75, s86, v38
  v_dot2_f32_bf16 v39, v75, s85, v39
  s_waitcnt vmcnt(6)
  v_dot2_f32_bf16 v32, v76, s86, v32
  v_dot2_f32_bf16 v33, v76, s85, v33
  v_dot2_f32_bf16 v34, v77, s86, v34
  v_dot2_f32_bf16 v35, v77, s85, v35
  v_dot2_f32_bf16 v36, v78, s86, v36
  v_dot2_f32_bf16 v37, v78, s85, v37
  v_dot2_f32_bf16 v38, v79, s86, v38
  v_dot2_f32_bf16 v39, v79, s85, v39
  s_waitcnt vmcnt(5)
  v_dot2_f32_bf16 v32, v80, s86, v32
  v_dot2_f32_bf16 v33, v80, s85, v33
  v_dot2_f32_bf16 v34, v81, s86, v34
  v_dot2_f32_bf16 v35, v81, s85, v35
  v_dot2_f32_bf16 v36, v82, s86, v36
  v_dot2_f32_bf16 v37, v82, s85, v37
  v_dot2_f32_bf16 v38, v83, s86, v38
  v_dot2_f32_bf16 v39, v83, s85, v39
  s_waitcnt vmcnt(4)
  v_dot2_f32_bf16 v32, v84, s86, v32
  v_dot2_f32_bf16 v33, v84, s85, v33
  v_dot2_f32_bf16 v34, v85, s86, v34
  v_dot2_f32_bf16 v35, v85, s85, v35
  v_dot2_f32_bf16 v36, v86, s86, v36
  v_dot2_f32_bf16 v37, v86, s85, v37
  v_dot2_f32_bf16 v38, v87, s86, v38
  v_dot2_f32_bf16 v39, v87, s85, v39
  s_waitcnt vmcnt(3)
  v_dot2_f32_bf16 v32, v88, s86, v32
  v_dot2_f32_bf16 v33, v88, s85, v33
  v_dot2_f32_bf16 v34, v89, s86, v34
  v_dot2_f32_bf16 v35, v89, s85, v35
  v_dot2_f32_bf16 v36, v90, s86, v36
  v_dot2_f32_bf16 v37, v90, s85, v37
  v_dot2_f32_bf16 v38, v91, s86, v38
  v_dot2_f32_bf16 v39, v91, s85, v39
  s_waitcnt vmcnt(2)
  v_dot2_f32_bf16 v32, v92, s86, v32
  v_dot2_f32_bf16 v33, v92, s85, v33
  v_dot2_f32_bf16 v34, v93, s86, v34
  v_dot2_f32_bf16 v35, v93, s85, v35
  v_dot2_f32_bf16 v36, v94, s86, v36
  v_dot2_f32_bf16 v37, v94, s85, v37
  v_dot2_f32_bf16 v38, v95, s86, v38
  v_dot2_f32_bf16 v39, v95, s85, v39
  s_waitcnt vmcnt(1)
  v_dot2_f32_bf16 v32, v96, s86, v32
  v_dot2_f32_bf16 v33, v96, s85, v33
  v_dot2_f32_bf16 v34, v97, s86, v34
  v_dot2_f32_bf16 v35, v97, s85, v35
  v_dot2_f32_bf16 v36, v98, s86, v36
  v_dot2_f32_bf16 v37, v98, s85, v37
  v_dot2_f32_bf16 v38, v99, s86, v38
  v_dot2_f32_bf16 v39, v99, s85, v39
  s_waitcnt vmcnt(0)
  v_dot2_f32_bf16 v32, v100, s86, v32
  v_dot2_f32_bf16 v33, v100, s85, v33
  v_dot2_f32_bf16 v34, v101, s86, v34
  v_dot2_f32_bf16 v35, v101, s85, v35
  v_dot2_f32_bf16 v36, v102, s86, v36
  v_dot2_f32_bf16 v37, v102, s85, v37
  v_dot2_f32_bf16 v38, v103, s86, v38
  v_dot2_f32_bf16 v39, v103, s85, v39
  s_nop 2
  v_cvt_pk_bf16_f32 v40, v32, v33
  v_cvt_pk_bf16_f32 v41, v34, v35
  v_cvt_pk_bf16_f32 v42, v36, v37
  v_cvt_pk_bf16_f32 v43, v38, v39
  buffer_store_dwordx2 v[40:41], v28, s[72:75], s60 offen
  buffer_store_dwordx2 v[42:43], v28, s[72:75], s60 offen offset:32
  s_mov_b64 exec, -1
L_fin4:
  s_endpgm
  s_endpgm
L_compute:
  s_getpc_b64 s[90:91]
L_pc:
  s_sub_u32 s90, s90, L_pc-concat_heads__gqa_block_cached__gqa_block_cached__near_ridge_kernel
  s_subb_u32 s91, s91, 0
  s_lshr_b32 s46, s2, 3
  s_lshl2_add_u32 s46, s46, s7
  s_mul_i32 s46, s46, 192
  s_min_u32 s46, s46, L_end-concat_heads__gqa_block_cached__gqa_block_cached__near_ridge_kernel-128
  s_load_dword s92, s[90:91], s46
  s_add_u32 s46, s46, 64
  s_load_dword s92, s[90:91], s46
  s_add_u32 s46, s46, 64
  s_min_u32 s46, s46, L_end-concat_heads__gqa_block_cached__gqa_block_cached__near_ridge_kernel
  s_load_dword s92, s[90:91], s46
  s_and_b32 s44, s7, 1
  s_lshr_b32 s45, s7, 1
  v_and_b32 v23, 15, v0
  v_lshrrev_b32 v24, 4, v0
  v_bfe_u32 v25, v0, 2, 2
  v_and_b32 v26, 3, v0
  v_and_b32 v27, 1, v24
  v_lshrrev_b32 v28, 1, v24
  v_lshlrev_b32 v26, 3, v26
  v_lshl_add_u32 v29, v27, 2, v25
  v_mul_u32_u24 v20, 1056, v29
  v_add_u32 v20, v20, v26
  v_lshl_add_u32 v30, v28, 9, v20
  s_lshl_b32 s46, s45, 8
  s_add_u32 s46, s46, 92160
  v_add_u32 v2, s46, v30
  v_lshl_add_u32 v30, v28, 8, v20
  s_lshl_b32 s46, s45, 7
  v_add_u32 v17, s46, v30
  v_mov_b32 v158, v17
  v_lshl_add_u32 v30, v28, 7, v20
  s_lshl_b32 s46, s45, 6
  s_add_u32 s46, s46, 67584
  v_add_u32 v18, s46, v30
  v_lshrrev_b32 v30, 1, v23
  v_xor_b32 v30, v30, v24
  v_lshlrev_b32 v30, 4, v30
  v_lshl_add_u32 v30, v23, 7, v30
  s_mul_i32 s47, s44, 6144
  s_add_u32 s46, s47, 125952
  v_add_u32 v3, s46, v30
  v_xor_b32 v30, 64, v30
  v_add_u32 v4, s46, v30
  v_and_b32 v31, 3, v0
  v_mul_u32_u24 v30, 1088, v25
  v_lshl_add_u32 v30, v31, 8, v30
  v_lshl_add_u32 v30, v27, 3, v30
  s_mul_i32 s46, s44, 13056
  s_add_u32 s46, s46, 112128
  v_add_u32 v30, s46, v30
  v_xor_b32 v31, v31, v28
  v_lshl_add_u32 v5, v31, 4, v30
  v_xor_b32 v31, 2, v31
  v_lshl_add_u32 v6, v31, 4, v30
  v_lshl_add_u32 v22, v24, 2, v25
  v_lshl_add_u32 v30, v22, 8, v26
  s_mul_i32 s46, s44, 12288
  s_add_u32 s46, s46, 138240
  v_add_u32 v30, s46, v30
  v_xor_b32 v31, 0, v29
  v_lshl_add_u32 v7, v31, 5, v30
  v_xor_b32 v31, 1, v29
  v_lshl_add_u32 v8, v31, 5, v30
  v_xor_b32 v31, 2, v29
  v_lshl_add_u32 v9, v31, 5, v30
  v_xor_b32 v31, 3, v29
  v_lshl_add_u32 v10, v31, 5, v30
  v_xor_b32 v31, 4, v29
  v_lshl_add_u32 v11, v31, 5, v30
  v_xor_b32 v31, 5, v29
  v_lshl_add_u32 v12, v31, 5, v30
  v_xor_b32 v31, 6, v29
  v_lshl_add_u32 v13, v31, 5, v30
  v_xor_b32 v31, 7, v29
  v_lshl_add_u32 v14, v31, 5, v30
  v_lshlrev_b32 v21, 4, v0
  s_mul_i32 s46, s45, 24576
  s_add_u32 s46, s46, s47
  v_add_u32 v16, s46, v21
  v_add_u32 v15, 114688, v16
  s_add_u32 s46, s47, 114688
  v_add_u32 v19, s46, v21
  v_mov_b64 v[160:161], 0
  v_mov_b64 v[162:163], 0
  v_mov_b64 v[164:165], 0
  v_mov_b64 v[166:167], 0
  v_mov_b64 v[168:169], 0
  v_mov_b64 v[170:171], 0
  v_mov_b64 v[172:173], 0
  v_mov_b64 v[174:175], 0
  v_mov_b64 v[176:177], 0
  v_mov_b64 v[178:179], 0
  v_mov_b64 v[180:181], 0
  v_mov_b64 v[182:183], 0
  v_mov_b64 v[184:185], 0
  v_mov_b64 v[186:187], 0
  v_mov_b64 v[188:189], 0
  v_mov_b64 v[190:191], 0
  v_mov_b64 v[192:193], 0
  v_mov_b64 v[194:195], 0
  v_mov_b64 v[196:197], 0
  v_mov_b64 v[198:199], 0
  v_mov_b64 v[200:201], 0
  v_mov_b64 v[202:203], 0
  v_mov_b64 v[204:205], 0
  v_mov_b64 v[206:207], 0
  v_mov_b64 v[208:209], 0
  v_mov_b64 v[210:211], 0
  v_mov_b64 v[212:213], 0
  v_mov_b64 v[214:215], 0
  v_mov_b64 v[216:217], 0
  v_mov_b64 v[218:219], 0
  v_mov_b64 v[220:221], 0
  v_mov_b64 v[222:223], 0
  v_mov_b64 v[224:225], 0
  v_mov_b64 v[226:227], 0
  v_mov_b64 v[228:229], 0
  v_mov_b64 v[230:231], 0
  v_mov_b64 v[232:233], 0
  v_mov_b64 v[234:235], 0
  v_mov_b64 v[236:237], 0
  v_mov_b64 v[238:239], 0
  v_mov_b64 v[240:241], 0
  v_mov_b64 v[242:243], 0
  v_mov_b64 v[244:245], 0
  v_mov_b64 v[246:247], 0
  v_mov_b64 v[248:249], 0
  v_mov_b64 v[250:251], 0
  v_mov_b64 v[252:253], 0
  v_mov_b64 v[254:255], 0
  v_mov_b32 v22, 0
  v_and_b32 v29, 7, v0
  v_lshlrev_b32 v29, 2, v29
  v_add_u32 v29, 101376, v29
  s_lshl_b32 s46, s7, 2
  s_add_u32 s46, s46, 101392
  v_mov_b32 v30, s46
  v_mov_b32 v20, 64
  s_and_b32 s46, s2, 7
  s_lshl3_add_u32 s46, s46, s5
  s_lshl2_add_u32 s46, s46, s71
  s_mul_i32 s54, s46, 49152
  s_lshl_b32 s52, s46, 8
  s_lshl3_add_u32 s52, s7, s52
  s_add_u32 s52, s52, 22020096
  s_add_u32 s55, s54, 4096
  s_add_u32 s56, s54, 12288
  s_add_u32 s57, s54, 16384
  s_lshl3_add_u32 s47, s4, s5
  s_lshl2_add_u32 s46, s47, s71
  s_lshl2_add_u32 s46, s46, s7
  s_lshl_b32 s53, s46, 7
  s_lshl3_add_u32 s53, s3, s53
  s_add_u32 s53, s53, 22085632
  s_lshl2_add_u32 s46, s46, s3
  s_mul_i32 s60, s46, 6144
  s_add_u32 s60, s60, 12582912
  s_lshl4_add_u32 s46, s47, s6
  s_lshl2_add_u32 s46, s46, s7
  s_lshl_b32 s86, s46, 3
  s_add_u32 s86, s86, 22118400
  s_mul_i32 s87, s46, 3072
  s_add_u32 s87, s87, 18874368
  s_mov_b32 s51, 0x3e0293ee
  s_mov_b32 s89, 8000000
  s_mov_b32 s48, 92160
  s_mov_b32 s49, 9
  s_mov_b32 s58, 557855248
  s_mov_b32 s59, 891371573
  s_mov_b32 s61, 4294918144
  s_mov_b32 s50, 12288
  s_mov_b32 s85, 0
  s_mov_b32 s88, 1
  s_waitcnt lgkmcnt(0)
  s_mov_b32 s28, s42
  s_mov_b32 s29, s43
  s_mov_b32 s30, 268435456
  s_mov_b32 s31, 0x20000
  s_mov_b32 s76, s82
  s_mov_b32 s77, s83
  s_mov_b32 s78, 256
  s_mov_b32 s79, 0x20000
  s_lshl1_add_u32 s46, s5, s44
  s_lshl4_add_u32 s46, s46, s6
  s_mul_i32 s46, s46, 12288
  s_load_dword s90, s[34:35], s46
  s_load_dword s90, s[36:37], s46
  s_lshl2_add_u32 s46, s3, s7
  s_mul_i32 s46, s46, 294912
  s_load_dword s90, s[40:41], s46
  s_load_dword s90, s[42:43], s54 glc
  s_load_dword s90, s[42:43], s60 glc
  s_load_dword s90, s[42:43], s87 glc
  s_load_dword s90, s[42:43], s52 glc
  s_load_dword s90, s[42:43], s53 glc
  s_load_dword s90, s[42:43], s86 glc
  s_sub_u32 s46, s7, s71
  s_mul_i32 s46, s46, 49152
  s_add_u32 s46, s46, s54
  s_load_dword s90, s[42:43], s46 glc
  s_mul_i32 s46, s5, 221184
  s_load_dword s90, s[80:81], s46
  s_add_u32 s83, s52, 128
  s_add_u32 s46, s2, s7
  s_cmp_lg_u32 s46, 0
  s_cbranch_scc1 L_nn
  s_memrealtime s[46:47]
  s_waitcnt lgkmcnt(0)
  s_or_b32 s46, s46, 1
  v_mov_b32 v156, s46
  v_mov_b32 v157, s47
  s_mov_b64 exec, 1
  buffer_store_dwordx2 v[156:157], v22, s[76:79], 0 offen sc1
  s_mov_b64 exec, -1
L_nn:
  s_barrier
  ds_read_b64_tr_b16 v[76:77], v2 offset:0
  ds_read_b64_tr_b16 v[78:79], v2 offset:8448
  ds_read_b128 v[108:111], v3 offset:0
  ds_read_b128 v[112:115], v3 offset:2048
  ds_read_b128 v[116:119], v3 offset:4096
  ds_read_b64_tr_b16 v[80:81], v2 offset:32
  ds_read_b64_tr_b16 v[82:83], v2 offset:8480
  ds_read_b64_tr_b16 v[84:85], v2 offset:64
  ds_read_b64_tr_b16 v[86:87], v2 offset:8512
  ds_read_b64_tr_b16 v[88:89], v2 offset:96
  ds_read_b64_tr_b16 v[90:91], v2 offset:8544
  ds_read_b64_tr_b16 v[92:93], v2 offset:128
  ds_read_b64_tr_b16 v[94:95], v2 offset:8576
  ds_read_b64_tr_b16 v[96:97], v2 offset:160
  ds_read_b64_tr_b16 v[98:99], v2 offset:8608
  ds_read_b64_tr_b16 v[100:101], v2 offset:192
  ds_read_b64_tr_b16 v[102:103], v2 offset:8640
  ds_read_b64_tr_b16 v[104:105], v2 offset:224
  ds_read_b64_tr_b16 v[106:107], v2 offset:8672
  ds_read_b64_tr_b16 v[32:33], v2 offset:16896
  ds_read_b64_tr_b16 v[34:35], v2 offset:25344
  ds_read_b64_tr_b16 v[36:37], v2 offset:16928
  ds_read_b64_tr_b16 v[38:39], v2 offset:25376
  s_branch L_q_h1
L_q_top:
  v_mfma_f32_16x16x32_bf16 v[160:163], v[32:35], v[64:67], v[160:163]
  v_add_u32 v2, s47, v2
  v_mfma_f32_16x16x32_bf16 v[192:195], v[32:35], v[68:71], v[192:195]
  ds_read_b64_tr_b16 v[76:77], v2 offset:0
  v_add_u32 v3, s47, v3
  v_mfma_f32_16x16x32_bf16 v[224:227], v[32:35], v[72:75], v[224:227]
  ds_read_b64_tr_b16 v[78:79], v2 offset:8448
  v_add_u32 v4, s47, v4
  v_mfma_f32_16x16x32_bf16 v[228:231], v[36:39], v[72:75], v[228:231]
  ds_read_b128 v[108:111], v3 offset:0
  v_mfma_f32_16x16x32_bf16 v[196:199], v[36:39], v[68:71], v[196:199]
  ds_read_b128 v[112:115], v3 offset:2048
  v_mfma_f32_16x16x32_bf16 v[164:167], v[36:39], v[64:67], v[164:167]
  ds_read_b128 v[116:119], v3 offset:4096
  v_mfma_f32_16x16x32_bf16 v[168:171], v[40:43], v[64:67], v[168:171]
  ds_read_b64_tr_b16 v[80:81], v2 offset:32
  v_mfma_f32_16x16x32_bf16 v[200:203], v[40:43], v[68:71], v[200:203]
  ds_read_b64_tr_b16 v[82:83], v2 offset:8480
  v_mfma_f32_16x16x32_bf16 v[232:235], v[40:43], v[72:75], v[232:235]
  ds_read_b64_tr_b16 v[84:85], v2 offset:64
  v_mfma_f32_16x16x32_bf16 v[236:239], v[44:47], v[72:75], v[236:239]
  ds_read_b64_tr_b16 v[86:87], v2 offset:8512
  v_mfma_f32_16x16x32_bf16 v[204:207], v[44:47], v[68:71], v[204:207]
  ds_read_b64_tr_b16 v[88:89], v2 offset:96
  v_mfma_f32_16x16x32_bf16 v[172:175], v[44:47], v[64:67], v[172:175]
  ds_read_b64_tr_b16 v[90:91], v2 offset:8544
  v_mfma_f32_16x16x32_bf16 v[176:179], v[48:51], v[64:67], v[176:179]
  ds_read_b64_tr_b16 v[92:93], v2 offset:128
  v_mfma_f32_16x16x32_bf16 v[208:211], v[48:51], v[68:71], v[208:211]
  ds_read_b64_tr_b16 v[94:95], v2 offset:8576
  v_mfma_f32_16x16x32_bf16 v[240:243], v[48:51], v[72:75], v[240:243]
  ds_read_b64_tr_b16 v[96:97], v2 offset:160
  v_mfma_f32_16x16x32_bf16 v[244:247], v[52:55], v[72:75], v[244:247]
  ds_read_b64_tr_b16 v[98:99], v2 offset:8608
  v_mfma_f32_16x16x32_bf16 v[212:215], v[52:55], v[68:71], v[212:215]
  ds_read_b64_tr_b16 v[100:101], v2 offset:192
  v_mfma_f32_16x16x32_bf16 v[180:183], v[52:55], v[64:67], v[180:183]
  ds_read_b64_tr_b16 v[102:103], v2 offset:8640
  v_mfma_f32_16x16x32_bf16 v[184:187], v[56:59], v[64:67], v[184:187]
  ds_read_b64_tr_b16 v[104:105], v2 offset:224
  v_mfma_f32_16x16x32_bf16 v[216:219], v[56:59], v[68:71], v[216:219]
  ds_read_b64_tr_b16 v[106:107], v2 offset:8672
  v_mfma_f32_16x16x32_bf16 v[248:251], v[56:59], v[72:75], v[248:251]
  ds_read_b64_tr_b16 v[32:33], v2 offset:16896
  v_mfma_f32_16x16x32_bf16 v[252:255], v[60:63], v[72:75], v[252:255]
  ds_read_b64_tr_b16 v[34:35], v2 offset:25344
  v_mfma_f32_16x16x32_bf16 v[220:223], v[60:63], v[68:71], v[220:223]
  ds_read_b64_tr_b16 v[36:37], v2 offset:16928
  v_mfma_f32_16x16x32_bf16 v[188:191], v[60:63], v[64:67], v[188:191]
  ds_read_b64_tr_b16 v[38:39], v2 offset:25376
L_q_h1:
  s_waitcnt lgkmcnt(15)
  v_mfma_f32_16x16x32_bf16 v[160:163], v[76:79], v[108:111], v[160:163]
  ds_read_b128 v[64:67], v4 offset:0
  v_mfma_f32_16x16x32_bf16 v[192:195], v[76:79], v[112:115], v[192:195]
  ds_read_b128 v[68:71], v4 offset:2048
  v_mfma_f32_16x16x32_bf16 v[224:227], v[76:79], v[116:119], v[224:227]
  ds_read_b128 v[72:75], v4 offset:4096
  v_mfma_f32_16x16x32_bf16 v[228:231], v[80:83], v[116:119], v[228:231]
  ds_read_b64_tr_b16 v[40:41], v2 offset:16960
  v_mfma_f32_16x16x32_bf16 v[196:199], v[80:83], v[112:115], v[196:199]
  ds_read_b64_tr_b16 v[42:43], v2 offset:25408
  v_mfma_f32_16x16x32_bf16 v[164:167], v[80:83], v[108:111], v[164:167]
  ds_read_b64_tr_b16 v[44:45], v2 offset:16992
  s_waitcnt lgkmcnt(15)
  v_mfma_f32_16x16x32_bf16 v[168:171], v[84:87], v[108:111], v[168:171]
  ds_read_b64_tr_b16 v[46:47], v2 offset:25440
  v_mfma_f32_16x16x32_bf16 v[200:203], v[84:87], v[112:115], v[200:203]
  ds_read_b64_tr_b16 v[48:49], v2 offset:17024
  v_mfma_f32_16x16x32_bf16 v[232:235], v[84:87], v[116:119], v[232:235]
  ds_read_b64_tr_b16 v[50:51], v2 offset:25472
  v_mfma_f32_16x16x32_bf16 v[236:239], v[88:91], v[116:119], v[236:239]
  ds_read_b64_tr_b16 v[52:53], v2 offset:17056
  v_mfma_f32_16x16x32_bf16 v[204:207], v[88:91], v[112:115], v[204:207]
  ds_read_b64_tr_b16 v[54:55], v2 offset:25504
  v_mfma_f32_16x16x32_bf16 v[172:175], v[88:91], v[108:111], v[172:175]
  ds_read_b64_tr_b16 v[56:57], v2 offset:17088
  v_mfma_f32_16x16x32_bf16 v[176:179], v[92:95], v[108:111], v[176:179]
  ds_read_b64_tr_b16 v[58:59], v2 offset:25536
  v_mfma_f32_16x16x32_bf16 v[208:211], v[92:95], v[112:115], v[208:211]
  ds_read_b64_tr_b16 v[60:61], v2 offset:17120
  v_mfma_f32_16x16x32_bf16 v[240:243], v[92:95], v[116:119], v[240:243]
  ds_read_b64_tr_b16 v[62:63], v2 offset:25568
  s_waitcnt lgkmcnt(15)
  v_mfma_f32_16x16x32_bf16 v[244:247], v[96:99], v[116:119], v[244:247]
  s_add_u32 s46, s48, 46080
  s_cmp_eq_u32 s46, 138240
  v_mfma_f32_16x16x32_bf16 v[212:215], v[96:99], v[112:115], v[212:215]
  s_cselect_b32 s46, 0, s46
  s_sub_u32 s47, s46, s48
  v_mfma_f32_16x16x32_bf16 v[180:183], v[96:99], v[108:111], v[180:183]
  s_mov_b32 s48, s46
  s_sub_u32 s49, s49, 1
  v_mfma_f32_16x16x32_bf16 v[184:187], v[100:103], v[108:111], v[184:187]
  s_cmp_lg_u32 s49, 0
  v_mfma_f32_16x16x32_bf16 v[216:219], v[100:103], v[112:115], v[216:219]
  v_mfma_f32_16x16x32_bf16 v[248:251], v[100:103], v[116:119], v[248:251]
  v_mfma_f32_16x16x32_bf16 v[252:255], v[104:107], v[116:119], v[252:255]
  v_mfma_f32_16x16x32_bf16 v[220:223], v[104:107], v[112:115], v[220:223]
  v_mfma_f32_16x16x32_bf16 v[188:191], v[104:107], v[108:111], v[188:191]
  s_waitcnt lgkmcnt(0)
  s_barrier
  s_cbranch_scc1 L_q_top
  buffer_load_dwordx2 v[156:157], v22, s[76:79], 0 offen sc1
  v_mfma_f32_16x16x32_bf16 v[160:163], v[32:35], v[64:67], v[160:163]
  ds_read_b64 v[76:77], v5 offset:0
  ds_read_b64 v[78:79], v6 offset:0
  v_mfma_f32_16x16x32_bf16 v[164:167], v[36:39], v[64:67], v[164:167]
  ds_read_b64 v[92:93], v5 offset:4352
  ds_read_b64 v[94:95], v6 offset:4352
  v_mfma_f32_16x16x32_bf16 v[168:171], v[40:43], v[64:67], v[168:171]
  ds_read_b64 v[108:109], v5 offset:8704
  ds_read_b64 v[110:111], v6 offset:8704
  v_cvt_pk_bf16_f32 v160, v160, v161
  v_cvt_pk_bf16_f32 v161, v162, v163
  v_mfma_f32_16x16x32_bf16 v[176:179], v[48:51], v[64:67], v[176:179]
  ds_read_b64 v[80:81], v5 offset:64
  v_cvt_pk_bf16_f32 v162, v164, v165
  v_cvt_pk_bf16_f32 v163, v166, v167
  v_mfma_f32_16x16x32_bf16 v[172:175], v[44:47], v[64:67], v[172:175]
  ds_read_b64 v[82:83], v6 offset:64
  v_cvt_pk_bf16_f32 v168, v168, v169
  v_cvt_pk_bf16_f32 v169, v170, v171
  v_mfma_f32_16x16x32_bf16 v[180:183], v[52:55], v[64:67], v[180:183]
  ds_read_b64 v[96:97], v5 offset:4416
  v_cvt_pk_bf16_f32 v176, v176, v177
  v_cvt_pk_bf16_f32 v177, v178, v179
  v_mfma_f32_16x16x32_bf16 v[184:187], v[56:59], v[64:67], v[184:187]
  ds_read_b64 v[98:99], v6 offset:4416
  v_cvt_pk_bf16_f32 v170, v172, v173
  v_cvt_pk_bf16_f32 v171, v174, v175
  s_waitcnt lgkmcnt(8)
  v_mfma_f32_16x16x32_bf16 v[164:167], v[76:79], v[160:163], 0
  ds_read_b64 v[112:113], v5 offset:8768
  v_cvt_pk_bf16_f32 v178, v180, v181
  v_cvt_pk_bf16_f32 v179, v182, v183
  v_mfma_f32_16x16x32_bf16 v[188:191], v[60:63], v[64:67], v[188:191]
  ds_read_b64 v[114:115], v6 offset:8768
  v_cvt_pk_bf16_f32 v184, v184, v185
  v_cvt_pk_bf16_f32 v185, v186, v187
  s_waitcnt lgkmcnt(8)
  v_mfma_f32_16x16x32_bf16 v[172:175], v[92:95], v[160:163], 0
  ds_read_b64 v[84:85], v5 offset:128
  ds_read_b64 v[86:87], v6 offset:128
  s_waitcnt lgkmcnt(8)
  v_mfma_f32_16x16x32_bf16 v[180:183], v[108:111], v[160:163], 0
  ds_read_b64 v[100:101], v5 offset:4480
  v_cvt_pk_bf16_f32 v186, v188, v189
  v_cvt_pk_bf16_f32 v187, v190, v191
  s_waitcnt lgkmcnt(7)
  v_mfma_f32_16x16x32_bf16 v[164:167], v[80:83], v[168:171], v[164:167]
  ds_read_b64 v[102:103], v6 offset:4480
  ds_read_b64 v[116:117], v5 offset:8832
  s_waitcnt lgkmcnt(7)
  v_mfma_f32_16x16x32_bf16 v[172:175], v[96:99], v[168:171], v[172:175]
  ds_read_b64 v[118:119], v6 offset:8832
  ds_read_b64 v[88:89], v5 offset:192
  v_mfma_f32_16x16x32_bf16 v[192:195], v[32:35], v[68:71], v[192:195]
  ds_read_b64 v[90:91], v6 offset:192
  ds_read_b64 v[104:105], v5 offset:4544
  v_mfma_f32_16x16x32_bf16 v[196:199], v[36:39], v[68:71], v[196:199]
  ds_read_b64 v[106:107], v6 offset:4544
  ds_read_b64 v[120:121], v5 offset:8896
  s_waitcnt lgkmcnt(11)
  v_mfma_f32_16x16x32_bf16 v[180:183], v[112:115], v[168:171], v[180:183]
  ds_read_b64 v[122:123], v6 offset:8896
  s_waitcnt lgkmcnt(10)
  v_mfma_f32_16x16x32_bf16 v[164:167], v[84:87], v[176:179], v[164:167]
  v_cvt_pk_bf16_f32 v192, v192, v193
  v_cvt_pk_bf16_f32 v193, v194, v195
  v_mfma_f32_16x16x32_bf16 v[200:203], v[40:43], v[68:71], v[200:203]
  v_cvt_pk_bf16_f32 v194, v196, v197
  v_cvt_pk_bf16_f32 v195, v198, v199
  s_waitcnt lgkmcnt(8)
  v_mfma_f32_16x16x32_bf16 v[172:175], v[100:103], v[176:179], v[172:175]
  s_waitcnt lgkmcnt(6)
  v_mfma_f32_16x16x32_bf16 v[180:183], v[116:119], v[176:179], v[180:183]
  s_waitcnt lgkmcnt(4)
  v_mfma_f32_16x16x32_bf16 v[164:167], v[88:91], v[184:187], v[164:167]
  v_mfma_f32_16x16x32_bf16 v[208:211], v[48:51], v[68:71], v[208:211]
  v_cvt_pk_bf16_f32 v200, v200, v201
  s_waitcnt lgkmcnt(2)
  v_mfma_f32_16x16x32_bf16 v[172:175], v[104:107], v[184:187], v[172:175]
  v_cvt_pk_bf16_f32 v201, v202, v203
  s_waitcnt lgkmcnt(0)
  v_mfma_f32_16x16x32_bf16 v[180:183], v[120:123], v[184:187], v[180:183]
  s_nop 0
  v_max3_f32 v23, v164, v165, v166
  v_mfma_f32_16x16x32_bf16 v[204:207], v[44:47], v[68:71], v[204:207]
  v_cvt_pk_bf16_f32 v208, v208, v209
  v_mfma_f32_16x16x32_bf16 v[224:227], v[32:35], v[72:75], v[224:227]
  v_cvt_pk_bf16_f32 v209, v210, v211
  v_mfma_f32_16x16x32_bf16 v[212:215], v[52:55], v[68:71], v[212:215]
  v_max3_f32 v26, v167, v172, v173
  v_max3_f32 v23, v23, v174, v175
  v_mfma_f32_16x16x32_bf16 v[216:219], v[56:59], v[68:71], v[216:219]
  v_max3_f32 v26, v26, v180, v181
  v_max3_f32 v23, v23, v182, v183
  v_mfma_f32_16x16x32_bf16 v[196:199], v[76:79], v[192:195], 0
  v_max_f32 v23, v23, v26
  v_mov_b32 v26, v23
  v_mfma_f32_16x16x32_bf16 v[220:223], v[60:63], v[68:71], v[220:223]
  s_nop 0
  v_permlane16_swap_b32 v23, v26
  v_max_f32 v23, v23, v26
  v_mfma_f32_16x16x32_bf16 v[228:231], v[36:39], v[72:75], v[228:231]
  v_mov_b32 v26, v23
  v_cvt_pk_bf16_f32 v202, v204, v205
  v_mfma_f32_16x16x32_bf16 v[232:235], v[40:43], v[72:75], v[232:235]
  v_permlane32_swap_b32 v23, v26
  v_max_f32 v23, v23, v26
  v_mfma_f32_16x16x32_bf16 v[240:243], v[48:51], v[72:75], v[240:243]
  v_mul_f32 v23, s51, v23
  v_fma_f32 v164, v164, s51, -v23
  v_mfma_f32_16x16x32_bf16 v[236:239], v[44:47], v[72:75], v[236:239]
  v_fma_f32 v183, v183, s51, -v23
  v_fma_f32 v165, v165, s51, -v23
  v_mfma_f32_16x16x32_bf16 v[244:247], v[52:55], v[72:75], v[244:247]
  ds_read_b32 v31, v29 offset:96
  v_fma_f32 v166, v166, s51, -v23
  v_fma_f32 v167, v167, s51, -v23
  v_mfma_f32_16x16x32_bf16 v[248:251], v[56:59], v[72:75], v[248:251]
  v_fma_f32 v172, v172, s51, -v23
  v_fma_f32 v173, v173, s51, -v23
  v_mfma_f32_16x16x32_bf16 v[252:255], v[60:63], v[72:75], v[252:255]
  v_exp_f32 v164, v164
  v_exp_f32 v165, v165
  v_exp_f32 v166, v166
  v_exp_f32 v167, v167
  v_fma_f32 v174, v174, s51, -v23
  v_fma_f32 v175, v175, s51, -v23
  v_exp_f32 v172, v172
  v_exp_f32 v173, v173
  v_fma_f32 v180, v180, s51, -v23
  v_fma_f32 v181, v181, s51, -v23
  v_fma_f32 v182, v182, s51, -v23
  v_add_f32 v23, v164, v165
  v_add_f32 v26, v166, v167
  v_exp_f32 v174, v174
  v_exp_f32 v175, v175
  s_waitcnt lgkmcnt(0)
  v_cmp_eq_u32 vcc, 0, v31
  v_add_f32 v23, v23, v172
  v_add_f32 v26, v26, v173
  v_exp_f32 v180, v180
  v_exp_f32 v181, v181
  v_add_f32 v23, v23, v174
  v_add_f32 v26, v26, v175
  v_exp_f32 v182, v182
  v_exp_f32 v183, v183
  v_add_f32 v23, v23, v180
  v_add_f32 v26, v26, v181
  v_add_f32 v23, v23, v182
  v_add_f32 v26, v26, v183
  v_add_f32 v23, v23, v26
  v_mov_b32 v26, v23
  v_cvt_pk_bf16_f32 v203, v206, v207
  v_mfma_f32_16x16x32_bf16 v[204:207], v[92:95], v[192:195], 0
  s_cbranch_vccnz L_vls
L_vlg:
  v_permlane16_swap_b32 v23, v26
  v_add_f32 v23, v23, v26
  v_mfma_f32_16x16x32_bf16 v[196:199], v[80:83], v[200:203], v[196:199]
  ds_read_b64_tr_b16 v[32:33], v7
  v_mov_b32 v26, v23
  v_cvt_pk_bf16_f32 v210, v212, v213
  v_mfma_f32_16x16x32_bf16 v[204:207], v[96:99], v[200:203], v[204:207]
  ds_read_b64_tr_b16 v[34:35], v7 offset:4096
  v_permlane32_swap_b32 v23, v26
  v_add_f32 v23, v23, v26
  v_rcp_f32 v23, v23
  v_cvt_pk_bf16_f32 v211, v214, v215
  v_mfma_f32_16x16x32_bf16 v[212:215], v[108:111], v[192:195], 0
  ds_read_b64_tr_b16 v[124:125], v7 offset:8192
  v_mul_f32 v164, v164, v23
  v_mul_f32 v165, v165, v23
  v_mfma_f32_16x16x32_bf16 v[212:215], v[112:115], v[200:203], v[212:215]
  ds_read_b64_tr_b16 v[36:37], v8
  v_cvt_pk_bf16_f32 v188, v164, v165
  v_mul_f32 v166, v166, v23
  v_mfma_f32_16x16x32_bf16 v[196:199], v[84:87], v[208:211], v[196:199]
  ds_read_b64_tr_b16 v[38:39], v8 offset:4096
  v_mul_f32 v167, v167, v23
  v_mul_f32 v172, v172, v23
  v_mfma_f32_16x16x32_bf16 v[204:207], v[100:103], v[208:211], v[204:207]
  ds_read_b64_tr_b16 v[126:127], v8 offset:8192
  v_mul_f32 v173, v173, v23
  v_mul_f32 v174, v174, v23
  v_mfma_f32_16x16x32_bf16 v[212:215], v[116:119], v[208:211], v[212:215]
  ds_read_b64_tr_b16 v[40:41], v9
  v_mul_f32 v175, v175, v23
  v_cvt_pk_bf16_f32 v189, v166, v167
  v_cvt_pk_bf16_f32 v190, v172, v173
  v_cvt_pk_bf16_f32 v191, v174, v175
  v_mul_f32 v180, v180, v23
  v_mul_f32 v181, v181, v23
  s_waitcnt lgkmcnt(5)
  v_mfma_f32_16x16x32_bf16 v[160:163], v[32:35], v[188:191], 0
  ds_read_b64_tr_b16 v[42:43], v9 offset:4096
  v_mul_f32 v182, v182, v23
  v_mul_f32 v183, v183, v23
  v_cvt_pk_bf16_f32 v180, v180, v181
  v_cvt_pk_bf16_f32 v181, v182, v183
  v_cvt_pk_bf16_f32 v216, v216, v217
  s_waitcnt lgkmcnt(3)
  v_mfma_f32_16x16x32_bf16 v[140:143], v[36:39], v[188:191], 0
  ds_read_b64_tr_b16 v[128:129], v9 offset:8192
  v_cvt_pk_bf16_f32 v217, v218, v219
  v_cvt_pk_bf16_f32 v218, v220, v221
  v_mfma_f32_16x16x16_bf16 v[160:163], v[124:125], v[180:181], v[160:163]
  ds_read_b64_tr_b16 v[44:45], v10
  v_cvt_pk_bf16_f32 v219, v222, v223
  v_cvt_pk_bf16_f32 v224, v224, v225
  s_waitcnt lgkmcnt(4)
  v_mfma_f32_16x16x16_bf16 v[140:143], v[126:127], v[180:181], v[140:143]
  ds_read_b64_tr_b16 v[46:47], v10 offset:4096
  v_cvt_pk_bf16_f32 v225, v226, v227
  v_cvt_pk_bf16_f32 v226, v228, v229
  v_mfma_f32_16x16x32_bf16 v[196:199], v[88:91], v[216:219], v[196:199]
  ds_read_b64_tr_b16 v[130:131], v10 offset:8192
  v_cvt_pk_bf16_f32 v160, v160, v161
  v_cvt_pk_bf16_f32 v161, v162, v163
  s_waitcnt lgkmcnt(4)
  v_mfma_f32_16x16x32_bf16 v[168:171], v[40:43], v[188:191], 0
  ds_read_b64_tr_b16 v[48:49], v11
  v_cvt_pk_bf16_f32 v162, v140, v141
  v_cvt_pk_bf16_f32 v163, v142, v143
  v_mfma_f32_16x16x32_bf16 v[204:207], v[104:107], v[216:219], v[204:207]
  buffer_store_dwordx4 v[160:163], v16, s[28:31], s54 offen offset:0 sc1
  v_max3_f32 v24, v196, v197, v198
  v_cvt_pk_bf16_f32 v227, v230, v231
  s_waitcnt lgkmcnt(4)
  v_mfma_f32_16x16x16_bf16 v[168:171], v[128:129], v[180:181], v[168:171]
  ds_read_b64_tr_b16 v[50:51], v11 offset:4096
  v_cvt_pk_bf16_f32 v232, v232, v233
  v_cvt_pk_bf16_f32 v233, v234, v235
  v_mfma_f32_16x16x32_bf16 v[212:215], v[120:123], v[216:219], v[212:215]
  ds_read_b64_tr_b16 v[132:133], v11 offset:8192
  v_max3_f32 v27, v199, v204, v205
  v_max3_f32 v24, v24, v206, v207
  s_waitcnt lgkmcnt(4)
  v_mfma_f32_16x16x32_bf16 v[144:147], v[44:47], v[188:191], 0
  ds_read_b64_tr_b16 v[52:53], v12
  v_cvt_pk_bf16_f32 v168, v168, v169
  v_cvt_pk_bf16_f32 v169, v170, v171
  v_mfma_f32_16x16x32_bf16 v[228:231], v[76:79], v[224:227], 0
  ds_read_b64_tr_b16 v[54:55], v12 offset:4096
  v_max3_f32 v27, v27, v212, v213
  v_max3_f32 v24, v24, v214, v215
  s_waitcnt lgkmcnt(5)
  v_mfma_f32_16x16x16_bf16 v[144:147], v[130:131], v[180:181], v[144:147]
  ds_read_b64_tr_b16 v[134:135], v12 offset:8192
  v_max_f32 v24, v24, v27
  v_mov_b32 v27, v24
  v_cvt_pk_bf16_f32 v240, v240, v241
  v_cvt_pk_bf16_f32 v234, v236, v237
  s_waitcnt lgkmcnt(4)
  v_mfma_f32_16x16x32_bf16 v[176:179], v[48:51], v[188:191], 0
  ds_read_b64_tr_b16 v[56:57], v13
  v_permlane16_swap_b32 v24, v27
  v_cvt_pk_bf16_f32 v170, v144, v145
  v_cvt_pk_bf16_f32 v171, v146, v147
  buffer_store_dwordx4 v[168:171], v16, s[28:31], s54 offen offset:1024 sc1
  v_max_f32 v24, v24, v27
  s_waitcnt lgkmcnt(4)
  v_mfma_f32_16x16x16_bf16 v[176:179], v[132:133], v[180:181], v[176:179]
  ds_read_b64_tr_b16 v[58:59], v13 offset:4096
  v_mov_b32 v27, v24
  v_cvt_pk_bf16_f32 v235, v238, v239
  v_mfma_f32_16x16x32_bf16 v[236:239], v[92:95], v[224:227], 0
  ds_read_b64_tr_b16 v[136:137], v13 offset:8192
  v_permlane32_swap_b32 v24, v27
  v_max_f32 v24, v24, v27
  v_mfma_f32_16x16x32_bf16 v[228:231], v[80:83], v[232:235], v[228:231]
  ds_read_b64_tr_b16 v[60:61], v14
  v_mul_f32 v24, s51, v24
  v_fma_f32 v196, v196, s51, -v24
  v_mfma_f32_16x16x32_bf16 v[236:239], v[96:99], v[232:235], v[236:239]
  ds_read_b64_tr_b16 v[62:63], v14 offset:4096
  v_fma_f32 v197, v197, s51, -v24
  v_fma_f32 v198, v198, s51, -v24
  s_waitcnt lgkmcnt(6)
  v_mfma_f32_16x16x32_bf16 v[148:151], v[52:55], v[188:191], 0
  ds_read_b64_tr_b16 v[138:139], v14 offset:8192
  v_fma_f32 v199, v199, s51, -v24
  v_fma_f32 v204, v204, s51, -v24
  v_fma_f32 v205, v205, s51, -v24
  v_exp_f32 v196, v196
  s_waitcnt lgkmcnt(4)
  v_mfma_f32_16x16x32_bf16 v[184:187], v[56:59], v[188:191], 0
  v_exp_f32 v197, v197
  v_exp_f32 v198, v198
  v_mfma_f32_16x16x16_bf16 v[148:151], v[134:135], v[180:181], v[148:151]
  v_exp_f32 v199, v199
  v_fma_f32 v206, v206, s51, -v24
  v_fma_f32 v207, v207, s51, -v24
  s_waitcnt lgkmcnt(3)
  v_mfma_f32_16x16x16_bf16 v[184:187], v[136:137], v[180:181], v[184:187]
  v_exp_f32 v204, v204
  v_exp_f32 v205, v205
  s_waitcnt lgkmcnt(1)
  v_mfma_f32_16x16x32_bf16 v[152:155], v[60:63], v[188:191], 0
  v_fma_f32 v212, v212, s51, -v24
  s_waitcnt lgkmcnt(0)
  ds_write_b32 v30, v20 offset:48
  v_fma_f32 v213, v213, s51, -v24
  v_fma_f32 v214, v214, s51, -v24
  v_fma_f32 v215, v215, s51, -v24
  v_add_f32 v24, v196, v197
  v_mfma_f32_16x16x16_bf16 v[152:155], v[138:139], v[180:181], v[152:155]
  ds_read_b32 v31, v29 offset:64
  v_add_f32 v27, v198, v199
  v_exp_f32 v206, v206
  v_exp_f32 v207, v207
  v_add_f32 v24, v24, v204
  v_add_f32 v27, v27, v205
  v_exp_f32 v212, v212
  v_exp_f32 v213, v213
  v_add_f32 v24, v24, v206
  v_add_f32 v27, v27, v207
  v_exp_f32 v214, v214
  v_exp_f32 v215, v215
  v_add_f32 v24, v24, v212
  v_add_f32 v27, v27, v213
  v_add_f32 v24, v24, v214
  v_add_f32 v27, v27, v215
  v_add_f32 v24, v24, v27
  v_mov_b32 v27, v24
  v_cvt_pk_bf16_f32 v241, v242, v243
  v_cvt_pk_bf16_f32 v242, v244, v245
  v_permlane16_swap_b32 v24, v27
  s_waitcnt lgkmcnt(0)
  v_cmp_eq_u32 vcc, 0, v31
  v_add_f32 v24, v24, v27
  v_mov_b32 v27, v24
  v_cvt_pk_bf16_f32 v243, v246, v247
  v_mfma_f32_16x16x32_bf16 v[244:247], v[108:111], v[224:227], 0
  s_cbranch_vccnz L_kvs
L_kvg:
  ds_write_b128 v15, v[160:163] offset:0
  ds_write_b128 v15, v[168:171] offset:1024
  v_permlane32_swap_b32 v24, v27
  v_add_f32 v24, v24, v27
  v_mfma_f32_16x16x32_bf16 v[244:247], v[112:115], v[232:235], v[244:247]
  v_rcp_f32 v24, v24
  v_cvt_pk_bf16_f32 v248, v248, v249
  v_mfma_f32_16x16x32_bf16 v[228:231], v[84:87], v[240:243], v[228:231]
  v_mul_f32 v196, v196, v24
  v_mul_f32 v197, v197, v24
  v_mfma_f32_16x16x32_bf16 v[236:239], v[100:103], v[240:243], v[236:239]
  v_mul_f32 v198, v198, v24
  v_mul_f32 v199, v199, v24
  v_mfma_f32_16x16x32_bf16 v[244:247], v[116:119], v[240:243], v[244:247]
  v_mul_f32 v204, v204, v24
  v_mul_f32 v205, v205, v24
  v_mul_f32 v206, v206, v24
  v_mul_f32 v207, v207, v24
  v_cvt_pk_bf16_f32 v220, v196, v197
  v_cvt_pk_bf16_f32 v221, v198, v199
  v_cvt_pk_bf16_f32 v222, v204, v205
  v_cvt_pk_bf16_f32 v223, v206, v207
  v_mul_f32 v212, v212, v24
  v_mul_f32 v213, v213, v24
  v_mfma_f32_16x16x32_bf16 v[192:195], v[32:35], v[220:223], 0
  v_mul_f32 v214, v214, v24
  v_mul_f32 v215, v215, v24
  v_mfma_f32_16x16x32_bf16 v[200:203], v[40:43], v[220:223], 0
  v_cvt_pk_bf16_f32 v212, v212, v213
  v_cvt_pk_bf16_f32 v213, v214, v215
  v_mfma_f32_16x16x32_bf16 v[76:79], v[36:39], v[220:223], 0
  v_cvt_pk_bf16_f32 v249, v250, v251
  v_cvt_pk_bf16_f32 v250, v252, v253
  v_mfma_f32_16x16x32_bf16 v[80:83], v[44:47], v[220:223], 0
  v_cvt_pk_bf16_f32 v251, v254, v255
  v_cvt_pk_bf16_f32 v176, v176, v177
  v_mfma_f32_16x16x16_bf16 v[192:195], v[124:125], v[212:213], v[192:195]
  v_cvt_pk_bf16_f32 v177, v178, v179
  v_cvt_pk_bf16_f32 v184, v184, v185
  v_mfma_f32_16x16x16_bf16 v[200:203], v[128:129], v[212:213], v[200:203]
  v_cvt_pk_bf16_f32 v178, v148, v149
  v_cvt_pk_bf16_f32 v179, v150, v151
  v_mfma_f32_16x16x16_bf16 v[76:79], v[126:127], v[212:213], v[76:79]
  ds_write_b128 v15, v[176:179] offset:12288
  v_cvt_pk_bf16_f32 v185, v186, v187
  v_cvt_pk_bf16_f32 v192, v192, v193
  v_mfma_f32_16x16x16_bf16 v[80:83], v[130:131], v[212:213], v[80:83]
  v_cvt_pk_bf16_f32 v193, v194, v195
  v_cvt_pk_bf16_f32 v200, v200, v201
  v_mfma_f32_16x16x32_bf16 v[228:231], v[88:91], v[248:251], v[228:231]
  s_nop 0
  v_cvt_pk_bf16_f32 v194, v76, v77
  v_cvt_pk_bf16_f32 v195, v78, v79
  v_mfma_f32_16x16x32_bf16 v[236:239], v[104:107], v[248:251], v[236:239]
  buffer_store_dwordx4 v[192:195], v16, s[28:31], s54 offen offset:2048 sc1
  v_cvt_pk_bf16_f32 v201, v202, v203
  v_cvt_pk_bf16_f32 v202, v80, v81
  v_mfma_f32_16x16x32_bf16 v[244:247], v[120:123], v[248:251], v[244:247]
  v_cvt_pk_bf16_f32 v203, v82, v83
  buffer_store_dwordx4 v[200:203], v16, s[28:31], s54 offen offset:3072 sc1
  buffer_store_dwordx4 v[176:179], v16, s[28:31], s56 offen offset:0 sc1
  v_max3_f32 v25, v228, v229, v230
  v_mfma_f32_16x16x32_bf16 v[208:211], v[48:51], v[220:223], 0
  v_max3_f32 v28, v231, v236, v237
  v_max3_f32 v25, v25, v238, v239
  v_mfma_f32_16x16x32_bf16 v[216:219], v[56:59], v[220:223], 0
  v_max3_f32 v28, v28, v244, v245
  v_max3_f32 v25, v25, v246, v247
  v_mfma_f32_16x16x32_bf16 v[84:87], v[52:55], v[220:223], 0
  v_max_f32 v25, v25, v28
  v_mov_b32 v28, v25
  v_mfma_f32_16x16x32_bf16 v[88:91], v[60:63], v[220:223], 0
  s_nop 0
  v_permlane16_swap_b32 v25, v28
  v_max_f32 v25, v25, v28
  v_mfma_f32_16x16x16_bf16 v[208:211], v[132:133], v[212:213], v[208:211]
  v_mov_b32 v28, v25
  v_cvt_pk_bf16_f32 v186, v152, v153
  v_mfma_f32_16x16x16_bf16 v[216:219], v[136:137], v[212:213], v[216:219]
  v_permlane32_swap_b32 v25, v28
  v_max_f32 v25, v25, v28
  v_mfma_f32_16x16x16_bf16 v[84:87], v[134:135], v[212:213], v[84:87]
  v_mul_f32 v25, s51, v25
  v_fma_f32 v228, v228, s51, -v25
  v_mfma_f32_16x16x16_bf16 v[88:91], v[138:139], v[212:213], v[88:91]
  v_fma_f32 v229, v229, s51, -v25
  v_fma_f32 v230, v230, s51, -v25
  v_fma_f32 v231, v231, s51, -v25
  v_fma_f32 v236, v236, s51, -v25
  v_fma_f32 v237, v237, s51, -v25
  v_exp_f32 v228, v228
  v_exp_f32 v229, v229
  v_exp_f32 v230, v230
  v_exp_f32 v231, v231
  v_fma_f32 v238, v238, s51, -v25
  v_fma_f32 v239, v239, s51, -v25
  v_exp_f32 v236, v236
  v_exp_f32 v237, v237
  v_fma_f32 v244, v244, s51, -v25
  v_fma_f32 v245, v245, s51, -v25
  v_fma_f32 v246, v246, s51, -v25
  v_fma_f32 v247, v247, s51, -v25
  v_add_f32 v25, v228, v229
  v_add_f32 v28, v230, v231
  v_exp_f32 v238, v238
  v_exp_f32 v239, v239
  v_add_f32 v25, v25, v236
  v_add_f32 v28, v28, v237
  v_exp_f32 v244, v244
  v_exp_f32 v245, v245
  v_add_f32 v25, v25, v238
  v_add_f32 v28, v28, v239
  v_exp_f32 v246, v246
  v_exp_f32 v247, v247
  v_add_f32 v25, v25, v244
  v_add_f32 v28, v28, v245
  v_add_f32 v25, v25, v246
  v_add_f32 v28, v28, v247
  v_add_f32 v25, v25, v28
  v_mov_b32 v28, v25
  v_cvt_pk_bf16_f32 v187, v154, v155
  buffer_store_dwordx4 v[184:187], v16, s[28:31], s56 offen offset:1024 sc1
  ds_write_b128 v15, v[184:187] offset:13312
  ds_write_b128 v15, v[192:195] offset:2048
  ds_write_b128 v15, v[200:203] offset:3072
  v_permlane16_swap_b32 v25, v28
  v_add_f32 v25, v25, v28
  v_mov_b32 v28, v25
  v_cvt_pk_bf16_f32 v208, v208, v209
  v_cvt_pk_bf16_f32 v209, v210, v211
  v_permlane32_swap_b32 v25, v28
  v_add_f32 v25, v25, v28
  v_rcp_f32 v25, v25
  v_cvt_pk_bf16_f32 v216, v216, v217
  v_mul_f32 v228, v228, v25
  v_mul_f32 v229, v229, v25
  v_mul_f32 v230, v230, v25
  v_mul_f32 v231, v231, v25
  v_mul_f32 v236, v236, v25
  v_mul_f32 v237, v237, v25
  v_mul_f32 v238, v238, v25
  v_mul_f32 v239, v239, v25
  v_cvt_pk_bf16_f32 v252, v228, v229
  v_cvt_pk_bf16_f32 v253, v230, v231
  v_cvt_pk_bf16_f32 v254, v236, v237
  v_cvt_pk_bf16_f32 v255, v238, v239
  v_mul_f32 v244, v244, v25
  v_mul_f32 v245, v245, v25
  v_mfma_f32_16x16x32_bf16 v[224:227], v[32:35], v[252:255], 0
  v_mul_f32 v246, v246, v25
  v_mul_f32 v247, v247, v25
  v_mfma_f32_16x16x32_bf16 v[232:235], v[40:43], v[252:255], 0
  v_cvt_pk_bf16_f32 v244, v244, v245
  v_cvt_pk_bf16_f32 v245, v246, v247
  v_mfma_f32_16x16x32_bf16 v[92:95], v[36:39], v[252:255], 0
  v_cvt_pk_bf16_f32 v210, v84, v85
  v_cvt_pk_bf16_f32 v211, v86, v87
  v_mfma_f32_16x16x32_bf16 v[96:99], v[44:47], v[252:255], 0
  buffer_store_dwordx4 v[208:211], v16, s[28:31], s56 offen offset:2048 sc1
  ds_write_b128 v15, v[208:211] offset:14336
  v_cvt_pk_bf16_f32 v217, v218, v219
  v_cvt_pk_bf16_f32 v218, v88, v89
  v_mfma_f32_16x16x16_bf16 v[224:227], v[124:125], v[244:245], v[224:227]
  v_cvt_pk_bf16_f32 v219, v90, v91
  buffer_store_dwordx4 v[216:219], v16, s[28:31], s56 offen offset:3072 sc1
  ds_write_b128 v15, v[216:219] offset:15360
  v_mfma_f32_16x16x16_bf16 v[232:235], v[128:129], v[244:245], v[232:235]
  v_mfma_f32_16x16x32_bf16 v[240:243], v[48:51], v[252:255], 0
  v_mfma_f32_16x16x32_bf16 v[248:251], v[56:59], v[252:255], 0
  s_nop 1
  v_cvt_pk_bf16_f32 v224, v224, v225
  v_mfma_f32_16x16x32_bf16 v[100:103], v[52:55], v[252:255], 0
  v_cvt_pk_bf16_f32 v225, v226, v227
  v_mfma_f32_16x16x16_bf16 v[92:95], v[126:127], v[244:245], v[92:95]
  v_cvt_pk_bf16_f32 v232, v232, v233
  v_mfma_f32_16x16x32_bf16 v[104:107], v[60:63], v[252:255], 0
  v_cvt_pk_bf16_f32 v233, v234, v235
  v_mfma_f32_16x16x16_bf16 v[240:243], v[132:133], v[244:245], v[240:243]
  v_mfma_f32_16x16x16_bf16 v[96:99], v[130:131], v[244:245], v[96:99]
  v_mfma_f32_16x16x16_bf16 v[248:251], v[136:137], v[244:245], v[248:251]
  s_nop 1
  v_cvt_pk_bf16_f32 v226, v92, v93
  v_mfma_f32_16x16x16_bf16 v[100:103], v[134:135], v[244:245], v[100:103]
  v_cvt_pk_bf16_f32 v227, v94, v95
  buffer_store_dwordx4 v[224:227], v16, s[28:31], s55 offen offset:0 sc1
  ds_write_b128 v15, v[224:227] offset:4096
  v_mfma_f32_16x16x16_bf16 v[104:107], v[138:139], v[244:245], v[104:107]
  v_cvt_pk_bf16_f32 v234, v96, v97
  v_cvt_pk_bf16_f32 v235, v98, v99
  buffer_store_dwordx4 v[232:235], v16, s[28:31], s55 offen offset:1024 sc1
  ds_write_b128 v15, v[232:235] offset:5120
  v_cvt_pk_bf16_f32 v240, v240, v241
  v_cvt_pk_bf16_f32 v241, v242, v243
  v_cvt_pk_bf16_f32 v248, v248, v249
  v_cvt_pk_bf16_f32 v242, v100, v101
  v_cvt_pk_bf16_f32 v243, v102, v103
  ds_write_b128 v15, v[240:243] offset:16384
  v_cvt_pk_bf16_f32 v249, v250, v251
  v_cvt_pk_bf16_f32 v250, v104, v105
  v_cvt_pk_bf16_f32 v251, v106, v107
  ds_write_b128 v15, v[248:251] offset:17408
  s_mov_b32 s48, 0
  s_mov_b32 s49, 0
  s_mov_b32 s91, 0
  s_waitcnt lgkmcnt(0)
  ds_write_b32 v30, v20
  v_add_u32 v30, 16, v30
  v_mov_b32 v20, 0
L_p0:
  ds_read_b32 v31, v29
  s_waitcnt lgkmcnt(0)
  v_cmp_ge_u32 vcc, s49, v31
  s_sub_u32 s89, s89, 1
  s_bitcmp1_b32 s89, 31
  s_cbranch_scc1 L_p0x
  s_cbranch_vccnz L_p0
L_p0x:
  ds_read_b64_tr_b16 v[32:33], v17 offset:0
  ds_read_b64_tr_b16 v[34:35], v17 offset:512
  ds_read_b128 v[56:59], v19 offset:0
  ds_read_b128 v[60:63], v19 offset:2048
  ds_read_b128 v[64:67], v19 offset:4096
  ds_read_b64_tr_b16 v[36:37], v17 offset:32
  ds_read_b64_tr_b16 v[38:39], v17 offset:544
  ds_read_b64_tr_b16 v[40:41], v17 offset:64
  ds_read_b64_tr_b16 v[42:43], v17 offset:576
  ds_read_b64_tr_b16 v[44:45], v17 offset:96
  ds_read_b64_tr_b16 v[46:47], v17 offset:608
  ds_read_b64_tr_b16 v[48:49], v18 offset:0
  ds_read_b64_tr_b16 v[50:51], v18 offset:256
  ds_read_b64_tr_b16 v[52:53], v18 offset:32
  ds_read_b64_tr_b16 v[54:55], v18 offset:288
  s_waitcnt lgkmcnt(12)
  v_mfma_f32_16x16x32_bf16 v[104:107], v[32:35], v[56:59], 0
  ds_read_b64_tr_b16 v[68:69], v17 offset:8448
  s_lshr_b64 s[58:59], s[58:59], 4
  s_waitcnt lgkmcnt(12)
  v_mfma_f32_16x16x32_bf16 v[108:111], v[32:35], v[60:63], 0
  ds_read_b64_tr_b16 v[70:71], v17 offset:8960
  s_and_b32 s46, s58, 15
  s_waitcnt lgkmcnt(12)
  v_mfma_f32_16x16x32_bf16 v[112:115], v[32:35], v[64:67], 0
  ds_read_b128 v[92:95], v19 offset:1024
  s_mul_i32 s46, s46, 16896
  s_waitcnt lgkmcnt(11)
  v_mfma_f32_16x16x32_bf16 v[116:119], v[36:39], v[56:59], 0
  ds_read_b128 v[96:99], v19 offset:3072
  s_cmp_eq_u32 s48, 3
  v_mfma_f32_16x16x32_bf16 v[120:123], v[36:39], v[60:63], 0
  ds_read_b128 v[100:103], v19 offset:5120
  s_cselect_b32 s47, s61, s50
  v_mfma_f32_16x16x32_bf16 v[124:127], v[36:39], v[64:67], 0
  ds_read_b64_tr_b16 v[72:73], v17 offset:8480
  s_add_u32 s48, s48, 1
  s_waitcnt lgkmcnt(12)
  v_mfma_f32_16x16x32_bf16 v[128:131], v[40:43], v[56:59], 0
  ds_read_b64_tr_b16 v[74:75], v17 offset:8992
  s_cmp_eq_u32 s48, 5
  v_mfma_f32_16x16x32_bf16 v[132:135], v[40:43], v[60:63], 0
  ds_read_b64_tr_b16 v[76:77], v17 offset:8512
  s_cselect_b32 s48, 0, s48
  v_mfma_f32_16x16x32_bf16 v[136:139], v[40:43], v[64:67], 0
  ds_read_b64_tr_b16 v[78:79], v17 offset:9024
  s_add_u32 s49, s49, 1
  s_waitcnt lgkmcnt(13)
  v_mfma_f32_16x16x32_bf16 v[140:143], v[44:47], v[56:59], 0
  ds_read_b32 v31, v29
  v_mfma_f32_16x16x32_bf16 v[144:147], v[44:47], v[60:63], 0
  ds_read_b64_tr_b16 v[80:81], v17 offset:8544
  v_mfma_f32_16x16x32_bf16 v[148:151], v[44:47], v[64:67], 0
  ds_read_b64_tr_b16 v[82:83], v17 offset:9056
  s_getreg_b32 s84, hwreg(HW_REG_IB_STS, 0, 4)
  s_waitcnt lgkmcnt(14)
  v_mfma_f32_16x16x32_bf16 v[160:163], v[48:51], v[56:59], 0
  ds_read_b64_tr_b16 v[84:85], v18 offset:512
  s_cmp_le_i32 s84, s85
  v_mfma_f32_16x16x32_bf16 v[164:167], v[48:51], v[60:63], 0
  ds_read_b64_tr_b16 v[86:87], v18 offset:768
  s_cbranch_scc1 L_stb1
L_bkb1:
  v_mfma_f32_16x16x32_bf16 v[168:171], v[48:51], v[64:67], 0
  ds_read_b64_tr_b16 v[88:89], v18 offset:544
  s_waitcnt lgkmcnt(15)
  v_mfma_f32_16x16x32_bf16 v[172:175], v[52:55], v[56:59], 0
  ds_read_b64_tr_b16 v[90:91], v18 offset:800
  v_mfma_f32_16x16x32_bf16 v[192:195], v[52:55], v[60:63], 0
  s_waitcnt lgkmcnt(6)
  v_cmp_ge_u32 vcc, s49, v31
  v_mfma_f32_16x16x32_bf16 v[196:199], v[52:55], v[64:67], 0
L_o_top:
  v_mfma_f32_16x16x32_bf16 v[104:107], v[68:71], v[92:95], v[104:107]
  v_add_u32 v17, s46, v158
  s_cbranch_vccnz L_spin0
L_go0:
  v_mfma_f32_16x16x32_bf16 v[108:111], v[68:71], v[96:99], v[108:111]
  ds_read_b64_tr_b16 v[32:33], v17 offset:0
  v_add_u32 v19, s47, v19
  v_mfma_f32_16x16x32_bf16 v[112:115], v[68:71], v[100:103], v[112:115]
  ds_read_b64_tr_b16 v[34:35], v17 offset:512
  v_add_u32 v18, 8448, v18
  v_mfma_f32_16x16x32_bf16 v[116:119], v[72:75], v[92:95], v[116:119]
  ds_read_b128 v[56:59], v19 offset:0
  v_add_u32 v20, 1, v20
  v_mfma_f32_16x16x32_bf16 v[120:123], v[72:75], v[96:99], v[120:123]
  ds_read_b128 v[60:63], v19 offset:2048
  s_getreg_b32 s84, hwreg(HW_REG_IB_STS, 0, 4)
  v_mfma_f32_16x16x32_bf16 v[124:127], v[72:75], v[100:103], v[124:127]
  ds_read_b128 v[64:67], v19 offset:4096
  s_cmp_le_i32 s84, s85
  v_mfma_f32_16x16x32_bf16 v[128:131], v[76:79], v[92:95], v[128:131]
  ds_read_b64_tr_b16 v[36:37], v17 offset:32
  s_cbranch_scc1 L_sta0
L_bka0:
  v_mfma_f32_16x16x32_bf16 v[132:135], v[76:79], v[96:99], v[132:135]
  ds_read_b64_tr_b16 v[38:39], v17 offset:544
  v_mfma_f32_16x16x32_bf16 v[136:139], v[76:79], v[100:103], v[136:139]
  ds_read_b64_tr_b16 v[40:41], v17 offset:64
  s_waitcnt lgkmcnt(12)
  v_mfma_f32_16x16x32_bf16 v[140:143], v[80:83], v[92:95], v[140:143]
  ds_read_b64_tr_b16 v[42:43], v17 offset:576
  v_mfma_f32_16x16x32_bf16 v[144:147], v[80:83], v[96:99], v[144:147]
  ds_read_b64_tr_b16 v[44:45], v17 offset:96
  v_mfma_f32_16x16x32_bf16 v[148:151], v[80:83], v[100:103], v[148:151]
  ds_read_b64_tr_b16 v[46:47], v17 offset:608
  s_waitcnt lgkmcnt(13)
  v_mfma_f32_16x16x32_bf16 v[160:163], v[84:87], v[92:95], v[160:163]
  ds_read_b64_tr_b16 v[48:49], v18 offset:0
  v_mfma_f32_16x16x32_bf16 v[164:167], v[84:87], v[96:99], v[164:167]
  ds_read_b64_tr_b16 v[50:51], v18 offset:256
  v_mfma_f32_16x16x32_bf16 v[168:171], v[84:87], v[100:103], v[168:171]
  ds_read_b64_tr_b16 v[52:53], v18 offset:32
  s_waitcnt lgkmcnt(14)
  v_mfma_f32_16x16x32_bf16 v[172:175], v[88:91], v[92:95], v[172:175]
  ds_read_b64_tr_b16 v[54:55], v18 offset:288
  v_mfma_f32_16x16x32_bf16 v[192:195], v[88:91], v[96:99], v[192:195]
  v_mfma_f32_16x16x32_bf16 v[196:199], v[88:91], v[100:103], v[196:199]
  ds_write_b32 v30, v20
  s_waitcnt lgkmcnt(13)
  v_mfma_f32_16x16x32_bf16 v[104:107], v[32:35], v[56:59], v[104:107]
  ds_read_b64_tr_b16 v[68:69], v17 offset:8448
  s_lshr_b64 s[58:59], s[58:59], 4
  s_waitcnt lgkmcnt(13)
  v_mfma_f32_16x16x32_bf16 v[108:111], v[32:35], v[60:63], v[108:111]
  ds_read_b64_tr_b16 v[70:71], v17 offset:8960
  s_and_b32 s46, s58, 15
  s_waitcnt lgkmcnt(13)
  v_mfma_f32_16x16x32_bf16 v[112:115], v[32:35], v[64:67], v[112:115]
  ds_read_b128 v[92:95], v19 offset:1024
  s_mul_i32 s46, s46, 16896
  s_waitcnt lgkmcnt(12)
  v_mfma_f32_16x16x32_bf16 v[116:119], v[36:39], v[56:59], v[116:119]
  ds_read_b128 v[96:99], v19 offset:3072
  s_cmp_eq_u32 s48, 3
  v_mfma_f32_16x16x32_bf16 v[120:123], v[36:39], v[60:63], v[120:123]
  ds_read_b128 v[100:103], v19 offset:5120
  s_cselect_b32 s47, s61, s50
  v_mfma_f32_16x16x32_bf16 v[124:127], v[36:39], v[64:67], v[124:127]
  ds_read_b64_tr_b16 v[72:73], v17 offset:8480
  s_add_u32 s48, s48, 1
  s_waitcnt lgkmcnt(13)
  v_mfma_f32_16x16x32_bf16 v[128:131], v[40:43], v[56:59], v[128:131]
  ds_read_b64_tr_b16 v[74:75], v17 offset:8992
  s_cmp_eq_u32 s48, 5
  v_mfma_f32_16x16x32_bf16 v[132:135], v[40:43], v[60:63], v[132:135]
  ds_read_b64_tr_b16 v[76:77], v17 offset:8512
  s_cselect_b32 s48, 0, s48
  v_mfma_f32_16x16x32_bf16 v[136:139], v[40:43], v[64:67], v[136:139]
  ds_read_b64_tr_b16 v[78:79], v17 offset:9024
  s_add_u32 s49, s49, 1
  s_waitcnt lgkmcnt(14)
  v_mfma_f32_16x16x32_bf16 v[140:143], v[44:47], v[56:59], v[140:143]
  ds_read_b32 v31, v29
  v_mfma_f32_16x16x32_bf16 v[144:147], v[44:47], v[60:63], v[144:147]
  ds_read_b64_tr_b16 v[80:81], v17 offset:8544
  v_mfma_f32_16x16x32_bf16 v[148:151], v[44:47], v[64:67], v[148:151]
  ds_read_b64_tr_b16 v[82:83], v17 offset:9056
  s_getreg_b32 s84, hwreg(HW_REG_IB_STS, 0, 4)
  s_waitcnt lgkmcnt(15)
  v_mfma_f32_16x16x32_bf16 v[160:163], v[48:51], v[56:59], v[160:163]
  ds_read_b64_tr_b16 v[84:85], v18 offset:512
  s_cmp_le_i32 s84, s85
  v_mfma_f32_16x16x32_bf16 v[164:167], v[48:51], v[60:63], v[164:167]
  ds_read_b64_tr_b16 v[86:87], v18 offset:768
  s_cbranch_scc1 L_stb0
L_bkb0:
  v_mfma_f32_16x16x32_bf16 v[168:171], v[48:51], v[64:67], v[168:171]
  ds_read_b64_tr_b16 v[88:89], v18 offset:544
  s_waitcnt lgkmcnt(15)
  v_mfma_f32_16x16x32_bf16 v[172:175], v[52:55], v[56:59], v[172:175]
  ds_read_b64_tr_b16 v[90:91], v18 offset:800
  v_mfma_f32_16x16x32_bf16 v[192:195], v[52:55], v[60:63], v[192:195]
  s_waitcnt lgkmcnt(6)
  v_cmp_ge_u32 vcc, s49, v31
  v_mfma_f32_16x16x32_bf16 v[196:199], v[52:55], v[64:67], v[196:199]
  s_cmp_lt_u32 s49, 4
  s_cbranch_scc1 L_o_top
  v_mfma_f32_16x16x32_bf16 v[104:107], v[68:71], v[92:95], v[104:107]
  v_add_u32 v17, s46, v158
  s_cbranch_vccnz L_spin1
L_go1:
  v_mfma_f32_16x16x32_bf16 v[108:111], v[68:71], v[96:99], v[108:111]
  ds_read_b64_tr_b16 v[32:33], v17 offset:0
  v_add_u32 v19, s47, v19
  v_mfma_f32_16x16x32_bf16 v[112:115], v[68:71], v[100:103], v[112:115]
  ds_read_b64_tr_b16 v[34:35], v17 offset:512
  v_add_u32 v20, 1, v20
  v_mfma_f32_16x16x32_bf16 v[116:119], v[72:75], v[92:95], v[116:119]
  ds_read_b128 v[56:59], v19 offset:0
  v_mfma_f32_16x16x32_bf16 v[120:123], v[72:75], v[96:99], v[120:123]
  ds_read_b128 v[60:63], v19 offset:2048
  s_getreg_b32 s84, hwreg(HW_REG_IB_STS, 0, 4)
  v_mfma_f32_16x16x32_bf16 v[124:127], v[72:75], v[100:103], v[124:127]
  ds_read_b128 v[64:67], v19 offset:4096
  s_cmp_le_i32 s84, s85
  v_mfma_f32_16x16x32_bf16 v[128:131], v[76:79], v[92:95], v[128:131]
  ds_read_b64_tr_b16 v[36:37], v17 offset:32
  s_cbranch_scc1 L_sta1
L_bka1:
  v_mfma_f32_16x16x32_bf16 v[132:135], v[76:79], v[96:99], v[132:135]
  ds_read_b64_tr_b16 v[38:39], v17 offset:544
  v_mfma_f32_16x16x32_bf16 v[136:139], v[76:79], v[100:103], v[136:139]
  ds_read_b64_tr_b16 v[40:41], v17 offset:64
  s_waitcnt lgkmcnt(12)
  v_mfma_f32_16x16x32_bf16 v[140:143], v[80:83], v[92:95], v[140:143]
  ds_read_b64_tr_b16 v[42:43], v17 offset:576
  v_mfma_f32_16x16x32_bf16 v[144:147], v[80:83], v[96:99], v[144:147]
  ds_read_b64_tr_b16 v[44:45], v17 offset:96
  v_mfma_f32_16x16x32_bf16 v[148:151], v[80:83], v[100:103], v[148:151]
  ds_read_b64_tr_b16 v[46:47], v17 offset:608
  s_waitcnt lgkmcnt(13)
  v_mfma_f32_16x16x32_bf16 v[160:163], v[84:87], v[92:95], v[160:163]
  v_mfma_f32_16x16x32_bf16 v[164:167], v[84:87], v[96:99], v[164:167]
  v_mfma_f32_16x16x32_bf16 v[168:171], v[84:87], v[100:103], v[168:171]
  s_waitcnt lgkmcnt(11)
  v_mfma_f32_16x16x32_bf16 v[172:175], v[88:91], v[92:95], v[172:175]
  v_mfma_f32_16x16x32_bf16 v[192:195], v[88:91], v[96:99], v[192:195]
  v_mfma_f32_16x16x32_bf16 v[196:199], v[88:91], v[100:103], v[196:199]
  ds_write_b32 v30, v20
  s_waitcnt lgkmcnt(9)
  v_mfma_f32_16x16x32_bf16 v[104:107], v[32:35], v[56:59], v[104:107]
  ds_read_b64_tr_b16 v[68:69], v17 offset:8448
  s_lshr_b64 s[58:59], s[58:59], 4
  s_waitcnt lgkmcnt(9)
  v_mfma_f32_16x16x32_bf16 v[108:111], v[32:35], v[60:63], v[108:111]
  ds_read_b64_tr_b16 v[70:71], v17 offset:8960
  s_and_b32 s46, s58, 15
  s_waitcnt lgkmcnt(9)
  v_mfma_f32_16x16x32_bf16 v[112:115], v[32:35], v[64:67], v[112:115]
  ds_read_b128 v[92:95], v19 offset:1024
  s_mul_i32 s46, s46, 16896
  v_cvt_pk_bf16_f32 v224, v160, v161
  v_cvt_pk_bf16_f32 v225, v162, v163
  s_waitcnt lgkmcnt(8)
  v_mfma_f32_16x16x32_bf16 v[116:119], v[36:39], v[56:59], v[116:119]
  ds_read_b128 v[96:99], v19 offset:3072
  s_cmp_eq_u32 s48, 3
  v_cvt_pk_bf16_f32 v226, v172, v173
  v_cvt_pk_bf16_f32 v227, v174, v175
  v_mfma_f32_16x16x32_bf16 v[120:123], v[36:39], v[60:63], v[120:123]
  ds_read_b128 v[100:103], v19 offset:5120
  s_cselect_b32 s47, s61, s50
  buffer_store_dwordx4 v[224:227], v21, s[28:31], s87 offen offset:0 sc1
  v_cvt_pk_bf16_f32 v228, v164, v165
  v_mfma_f32_16x16x32_bf16 v[124:127], v[36:39], v[64:67], v[124:127]
  ds_read_b32 v31, v29
  s_add_u32 s48, s48, 1
  v_cvt_pk_bf16_f32 v229, v166, v167
  v_cvt_pk_bf16_f32 v230, v192, v193
  s_waitcnt lgkmcnt(9)
  v_mfma_f32_16x16x32_bf16 v[128:131], v[40:43], v[56:59], v[128:131]
  ds_read_b64_tr_b16 v[72:73], v17 offset:8480
  s_cmp_eq_u32 s48, 5
  v_cvt_pk_bf16_f32 v231, v194, v195
  buffer_store_dwordx4 v[228:231], v21, s[28:31], s87 offen offset:1024 sc1
  v_mfma_f32_16x16x32_bf16 v[132:135], v[40:43], v[60:63], v[132:135]
  ds_read_b64_tr_b16 v[74:75], v17 offset:8992
  s_cselect_b32 s48, 0, s48
  v_cvt_pk_bf16_f32 v232, v168, v169
  v_cvt_pk_bf16_f32 v233, v170, v171
  v_mfma_f32_16x16x32_bf16 v[136:139], v[40:43], v[64:67], v[136:139]
  ds_read_b64_tr_b16 v[76:77], v17 offset:8512
  s_add_u32 s49, s49, 1
  v_cvt_pk_bf16_f32 v234, v196, v197
  v_cvt_pk_bf16_f32 v235, v198, v199
  s_waitcnt lgkmcnt(10)
  v_mfma_f32_16x16x32_bf16 v[140:143], v[44:47], v[56:59], v[140:143]
  ds_read_b64_tr_b16 v[78:79], v17 offset:9024
  buffer_store_dwordx4 v[232:235], v21, s[28:31], s87 offen offset:2048 sc1
  v_mfma_f32_16x16x32_bf16 v[144:147], v[44:47], v[60:63], v[144:147]
  ds_read_b64_tr_b16 v[80:81], v17 offset:8544
  s_waitcnt lgkmcnt(5)
  v_cmp_ge_u32 vcc, s49, v31
  v_mfma_f32_16x16x32_bf16 v[148:151], v[44:47], v[64:67], v[148:151]
  ds_read_b64_tr_b16 v[82:83], v17 offset:9056
  s_or_b32 s88, s88, 4
  s_mov_b32 s85, 0
L_r_top:
  v_mfma_f32_16x16x32_bf16 v[104:107], v[68:71], v[92:95], v[104:107]
  v_add_u32 v17, s46, v158
  s_cbranch_vccnz L_spin2
L_go2:
  v_mfma_f32_16x16x32_bf16 v[108:111], v[68:71], v[96:99], v[108:111]
  ds_read_b64_tr_b16 v[32:33], v17 offset:0
  v_add_u32 v19, s47, v19
  v_mfma_f32_16x16x32_bf16 v[112:115], v[68:71], v[100:103], v[112:115]
  ds_read_b64_tr_b16 v[34:35], v17 offset:512
  v_add_u32 v20, 1, v20
  s_waitcnt lgkmcnt(6)
  v_mfma_f32_16x16x32_bf16 v[116:119], v[72:75], v[92:95], v[116:119]
  ds_read_b128 v[56:59], v19 offset:0
  v_mfma_f32_16x16x32_bf16 v[120:123], v[72:75], v[96:99], v[120:123]
  ds_read_b128 v[60:63], v19 offset:2048
  s_getreg_b32 s84, hwreg(HW_REG_IB_STS, 0, 4)
  v_mfma_f32_16x16x32_bf16 v[124:127], v[72:75], v[100:103], v[124:127]
  ds_read_b128 v[64:67], v19 offset:4096
  s_cmp_le_i32 s84, s85
  s_waitcnt lgkmcnt(7)
  v_mfma_f32_16x16x32_bf16 v[128:131], v[76:79], v[92:95], v[128:131]
  ds_read_b64_tr_b16 v[36:37], v17 offset:32
  s_cbranch_scc1 L_sta2
L_bka2:
  v_mfma_f32_16x16x32_bf16 v[132:135], v[76:79], v[96:99], v[132:135]
  ds_read_b64_tr_b16 v[38:39], v17 offset:544
  v_mfma_f32_16x16x32_bf16 v[136:139], v[76:79], v[100:103], v[136:139]
  ds_read_b64_tr_b16 v[40:41], v17 offset:64
  s_waitcnt lgkmcnt(8)
  v_mfma_f32_16x16x32_bf16 v[140:143], v[80:83], v[92:95], v[140:143]
  ds_read_b64_tr_b16 v[42:43], v17 offset:576
  v_mfma_f32_16x16x32_bf16 v[144:147], v[80:83], v[96:99], v[144:147]
  ds_read_b64_tr_b16 v[44:45], v17 offset:96
  v_mfma_f32_16x16x32_bf16 v[148:151], v[80:83], v[100:103], v[148:151]
  ds_read_b64_tr_b16 v[46:47], v17 offset:608
  ds_write_b32 v30, v20
  s_waitcnt lgkmcnt(9)
  v_mfma_f32_16x16x32_bf16 v[104:107], v[32:35], v[56:59], v[104:107]
  ds_read_b64_tr_b16 v[68:69], v17 offset:8448
  s_lshr_b64 s[58:59], s[58:59], 4
  s_waitcnt lgkmcnt(9)
  v_mfma_f32_16x16x32_bf16 v[108:111], v[32:35], v[60:63], v[108:111]
  ds_read_b64_tr_b16 v[70:71], v17 offset:8960
  s_and_b32 s46, s58, 15
  s_waitcnt lgkmcnt(9)
  v_mfma_f32_16x16x32_bf16 v[112:115], v[32:35], v[64:67], v[112:115]
  ds_read_b128 v[92:95], v19 offset:1024
  s_mul_i32 s46, s46, 16896
  s_waitcnt lgkmcnt(8)
  v_mfma_f32_16x16x32_bf16 v[116:119], v[36:39], v[56:59], v[116:119]
  ds_read_b128 v[96:99], v19 offset:3072
  s_cmp_eq_u32 s48, 3
  v_mfma_f32_16x16x32_bf16 v[120:123], v[36:39], v[60:63], v[120:123]
  ds_read_b128 v[100:103], v19 offset:5120
  s_cselect_b32 s47, s61, s50
  v_mfma_f32_16x16x32_bf16 v[124:127], v[36:39], v[64:67], v[124:127]
  ds_read_b32 v31, v29
  s_add_u32 s48, s48, 1
  s_waitcnt lgkmcnt(9)
  v_mfma_f32_16x16x32_bf16 v[128:131], v[40:43], v[56:59], v[128:131]
  ds_read_b64_tr_b16 v[72:73], v17 offset:8480
  s_cmp_eq_u32 s48, 5
  v_mfma_f32_16x16x32_bf16 v[132:135], v[40:43], v[60:63], v[132:135]
  ds_read_b64_tr_b16 v[74:75], v17 offset:8992
  s_cselect_b32 s48, 0, s48
  v_mfma_f32_16x16x32_bf16 v[136:139], v[40:43], v[64:67], v[136:139]
  ds_read_b64_tr_b16 v[76:77], v17 offset:8512
  s_add_u32 s49, s49, 1
  s_waitcnt lgkmcnt(10)
  v_mfma_f32_16x16x32_bf16 v[140:143], v[44:47], v[56:59], v[140:143]
  ds_read_b64_tr_b16 v[78:79], v17 offset:9024
  v_mfma_f32_16x16x32_bf16 v[144:147], v[44:47], v[60:63], v[144:147]
  ds_read_b64_tr_b16 v[80:81], v17 offset:8544
  s_waitcnt lgkmcnt(5)
  v_cmp_ge_u32 vcc, s49, v31
  v_mfma_f32_16x16x32_bf16 v[148:151], v[44:47], v[64:67], v[148:151]
  ds_read_b64_tr_b16 v[82:83], v17 offset:9056
  s_cmp_lt_u32 s49, 16
  s_cbranch_scc1 L_r_top
L_e0:
  s_cmp_eq_u32 s88, 0
  s_cbranch_scc1 L_e1
  s_call_b64 s[94:95], L_sendw
  s_branch L_e0
L_e1:
  s_waitcnt lgkmcnt(0)
  s_add_u32 s61, s60, 4096
  s_cmp_eq_u32 s7, s3
  s_cbranch_scc1 L_own
  v_mfma_f32_16x16x32_bf16 v[104:107], v[68:71], v[92:95], v[104:107]
  v_mfma_f32_16x16x32_bf16 v[116:119], v[72:75], v[92:95], v[116:119]
  v_mfma_f32_16x16x32_bf16 v[128:131], v[76:79], v[92:95], v[128:131]
  v_mfma_f32_16x16x32_bf16 v[140:143], v[80:83], v[92:95], v[140:143]
  v_mfma_f32_16x16x32_bf16 v[108:111], v[68:71], v[96:99], v[108:111]
  v_mfma_f32_16x16x32_bf16 v[120:123], v[72:75], v[96:99], v[120:123]
  v_mfma_f32_16x16x32_bf16 v[132:135], v[76:79], v[96:99], v[132:135]
  s_nop 1
  v_cvt_pk_bf16_f32 v184, v104, v105
  v_mfma_f32_16x16x32_bf16 v[144:147], v[80:83], v[96:99], v[144:147]
  v_cvt_pk_bf16_f32 v185, v106, v107
  v_cvt_pk_bf16_f32 v186, v116, v117
  v_mfma_f32_16x16x32_bf16 v[112:115], v[68:71], v[100:103], v[112:115]
  v_cvt_pk_bf16_f32 v187, v118, v119
  buffer_store_dwordx4 v[184:187], v21, s[28:31], s60 offen offset:0 sc1
  v_cvt_pk_bf16_f32 v188, v128, v129
  v_mfma_f32_16x16x32_bf16 v[124:127], v[72:75], v[100:103], v[124:127]
  v_cvt_pk_bf16_f32 v189, v130, v131
  v_cvt_pk_bf16_f32 v190, v140, v141
  v_mfma_f32_16x16x32_bf16 v[136:139], v[76:79], v[100:103], v[136:139]
  v_cvt_pk_bf16_f32 v191, v142, v143
  buffer_store_dwordx4 v[188:191], v21, s[28:31], s60 offen offset:1024 sc1
  v_cvt_pk_bf16_f32 v192, v108, v109
  v_mfma_f32_16x16x32_bf16 v[148:151], v[80:83], v[100:103], v[148:151]
  v_cvt_pk_bf16_f32 v193, v110, v111
  v_cvt_pk_bf16_f32 v194, v120, v121
  v_cvt_pk_bf16_f32 v195, v122, v123
  buffer_store_dwordx4 v[192:195], v21, s[28:31], s60 offen offset:2048 sc1
  v_cvt_pk_bf16_f32 v196, v132, v133
  v_cvt_pk_bf16_f32 v197, v134, v135
  v_cvt_pk_bf16_f32 v198, v144, v145
  v_cvt_pk_bf16_f32 v199, v146, v147
  buffer_store_dwordx4 v[196:199], v21, s[28:31], s60 offen offset:3072 sc1
  v_cvt_pk_bf16_f32 v200, v112, v113
  v_cvt_pk_bf16_f32 v201, v114, v115
  v_cvt_pk_bf16_f32 v202, v124, v125
  v_cvt_pk_bf16_f32 v203, v126, v127
  buffer_store_dwordx4 v[200:203], v21, s[28:31], s61 offen offset:0 sc1
  v_cvt_pk_bf16_f32 v204, v136, v137
  v_cvt_pk_bf16_f32 v205, v138, v139
  v_cvt_pk_bf16_f32 v206, v148, v149
  v_cvt_pk_bf16_f32 v207, v150, v151
  buffer_store_dwordx4 v[204:207], v21, s[28:31], s61 offen offset:1024 sc1
  s_waitcnt vmcnt(0)
L_own2:
  v_readfirstlane_b32 s92, v156
  v_readfirstlane_b32 s93, v157
  s_nop 3
  s_atomic_swap_x2 s[92:93], s[28:29], s53
  s_endpgm
L_own:
  v_add_u32 v21, 0, v21
  v_mov_b32 v30, 101424
  v_mfma_f32_16x16x32_bf16 v[104:107], v[68:71], v[92:95], v[104:107]
  v_mfma_f32_16x16x32_bf16 v[116:119], v[72:75], v[92:95], v[116:119]
  v_mfma_f32_16x16x32_bf16 v[128:131], v[76:79], v[92:95], v[128:131]
  v_mfma_f32_16x16x32_bf16 v[140:143], v[80:83], v[92:95], v[140:143]
  v_mfma_f32_16x16x32_bf16 v[108:111], v[68:71], v[96:99], v[108:111]
  v_mfma_f32_16x16x32_bf16 v[120:123], v[72:75], v[96:99], v[120:123]
  v_mfma_f32_16x16x32_bf16 v[132:135], v[76:79], v[96:99], v[132:135]
  s_nop 1
  v_cvt_pk_bf16_f32 v184, v104, v105
  v_mfma_f32_16x16x32_bf16 v[144:147], v[80:83], v[96:99], v[144:147]
  v_cvt_pk_bf16_f32 v185, v106, v107
  v_cvt_pk_bf16_f32 v186, v116, v117
  v_mfma_f32_16x16x32_bf16 v[112:115], v[68:71], v[100:103], v[112:115]
  v_cvt_pk_bf16_f32 v187, v118, v119
  ds_write_b128 v21, v[184:187] offset:0
  v_cvt_pk_bf16_f32 v188, v128, v129
  v_mfma_f32_16x16x32_bf16 v[124:127], v[72:75], v[100:103], v[124:127]
  v_cvt_pk_bf16_f32 v189, v130, v131
  v_cvt_pk_bf16_f32 v190, v140, v141
  v_mfma_f32_16x16x32_bf16 v[136:139], v[76:79], v[100:103], v[136:139]
  v_cvt_pk_bf16_f32 v191, v142, v143
  ds_write_b128 v21, v[188:191] offset:1024
  v_cvt_pk_bf16_f32 v192, v108, v109
  v_mfma_f32_16x16x32_bf16 v[148:151], v[80:83], v[100:103], v[148:151]
  v_cvt_pk_bf16_f32 v193, v110, v111
  v_cvt_pk_bf16_f32 v194, v120, v121
  v_cvt_pk_bf16_f32 v195, v122, v123
  ds_write_b128 v21, v[192:195] offset:2048
  v_cvt_pk_bf16_f32 v196, v132, v133
  v_cvt_pk_bf16_f32 v197, v134, v135
  v_cvt_pk_bf16_f32 v198, v144, v145
  v_cvt_pk_bf16_f32 v199, v146, v147
  ds_write_b128 v21, v[196:199] offset:3072
  v_cvt_pk_bf16_f32 v200, v112, v113
  v_cvt_pk_bf16_f32 v201, v114, v115
  v_cvt_pk_bf16_f32 v202, v124, v125
  v_cvt_pk_bf16_f32 v203, v126, v127
  ds_write_b128 v21, v[200:203] offset:4096
  v_cvt_pk_bf16_f32 v204, v136, v137
  v_cvt_pk_bf16_f32 v205, v138, v139
  v_cvt_pk_bf16_f32 v206, v148, v149
  v_cvt_pk_bf16_f32 v207, v150, v151
  ds_write_b128 v21, v[204:207] offset:5120
  s_waitcnt lgkmcnt(0)
  ds_write_b32 v30, v20
  s_branch L_own2
L_spin0:
L_sp0:
  s_cmp_eq_u32 s88, 0
  s_cbranch_scc1 L_sq0
  s_call_b64 s[94:95], L_sendw
L_sq0:
  ds_read_b32 v31, v29
  s_waitcnt lgkmcnt(0)
  v_cmp_ge_u32 vcc, s49, v31
  s_sub_u32 s89, s89, 1
  s_bitcmp1_b32 s89, 31
  s_cbranch_scc1 L_go0
  s_cbranch_vccnz L_sp0
  s_branch L_go0
L_spin1:
L_sp1:
  s_cmp_eq_u32 s88, 0
  s_cbranch_scc1 L_sq1
  s_call_b64 s[94:95], L_sendw
L_sq1:
  ds_read_b32 v31, v29
  s_waitcnt lgkmcnt(0)
  v_cmp_ge_u32 vcc, s49, v31
  s_sub_u32 s89, s89, 1
  s_bitcmp1_b32 s89, 31
  s_cbranch_scc1 L_go1
  s_cbranch_vccnz L_sp1
  s_branch L_go1
L_spin2:
L_sp2:
  s_cmp_eq_u32 s88, 0
  s_cbranch_scc1 L_sq2
  s_call_b64 s[94:95], L_sendw
L_sq2:
  ds_read_b32 v31, v29
  s_waitcnt lgkmcnt(0)
  v_cmp_ge_u32 vcc, s49, v31
  s_sub_u32 s89, s89, 1
  s_bitcmp1_b32 s89, 31
  s_cbranch_scc1 L_go2
  s_cbranch_vccnz L_sp2
  s_branch L_go2
L_sendw:
L_send:
  s_waitcnt vmcnt(0)
L_fn:
  v_readfirstlane_b32 s92, v156
  v_readfirstlane_b32 s93, v157
  s_sub_u32 s89, s89, 1
  s_bitcmp1_b32 s89, 31
  s_cbranch_scc1 L_fg
  s_cmp_lg_u32 s92, 0
  s_cbranch_scc1 L_fg
  buffer_load_dwordx2 v[156:157], v22, s[76:79], 0 offen sc1
  s_waitcnt vmcnt(0)
  s_branch L_fn
L_fg:
  s_bitcmp1_b32 s88, 0
  s_cbranch_scc0 L_s1
  s_bitcmp1_b32 s88, 3
  s_cbranch_scc1 L_s0
  s_atomic_swap_x2 s[92:93], s[28:29], s52
L_s0:
  buffer_store_dwordx4 v[240:243], v16, s[28:31], s57 offen offset:0 sc1
  buffer_store_dwordx4 v[248:251], v16, s[28:31], s57 offen offset:1024 sc1
  s_xor_b32 s88, s88, 3
  s_setpc_b64 s[94:95]
L_s1:
  s_bitcmp1_b32 s88, 1
  s_cbranch_scc0 L_s2
  s_atomic_swap_x2 s[92:93], s[28:29], s83
L_s2:
  s_bitcmp1_b32 s88, 2
  s_cbranch_scc0 L_s3
  s_atomic_swap_x2 s[92:93], s[28:29], s86
L_s3:
  s_mov_b32 s88, 0
  s_mov_b32 s85, -1
  s_setpc_b64 s[94:95]
L_stb1:
  s_call_b64 s[94:95], L_send
  s_branch L_bkb1
L_sta0:
  s_call_b64 s[94:95], L_send
  s_branch L_bka0
L_stb0:
  s_call_b64 s[94:95], L_send
  s_branch L_bkb0
L_sta1:
  s_call_b64 s[94:95], L_send
  s_branch L_bka1
L_sta2:
  s_call_b64 s[94:95], L_send
  s_branch L_bka2
L_kvs:
L_kvs2:
  ds_read_b32 v31, v29 offset:64
  s_waitcnt lgkmcnt(0)
  v_cmp_eq_u32 vcc, 0, v31
  s_sub_u32 s89, s89, 1
  s_bitcmp1_b32 s89, 31
  s_cbranch_scc1 L_kvg
  s_cbranch_vccnz L_kvs2
  s_branch L_kvg
L_vls:
L_vls2:
  ds_read_b32 v31, v29 offset:96
  s_waitcnt lgkmcnt(0)
  v_cmp_eq_u32 vcc, 0, v31
  s_sub_u32 s89, s89, 1
  s_bitcmp1_b32 s89, 31
  s_cbranch_scc1 L_vlg
  s_cbranch_vccnz L_vls2
  s_branch L_vlg
L_end:
s_endpgm
.section .rodata,"a"
.p2align 6
.amdhsa_kernel concat_heads__gqa_block_cached__gqa_block_cached__near_ridge_kernel
  .amdhsa_next_free_vgpr 256
  .amdhsa_next_free_sgpr 102
  .amdhsa_accum_offset 256
  .amdhsa_group_segment_fixed_size 0
  .amdhsa_kernarg_size 104
  .amdhsa_user_sgpr_count 2
  .amdhsa_user_sgpr_kernarg_segment_ptr 1
  .amdhsa_system_sgpr_workgroup_id_x 1
.end_amdhsa_kernel
```
